```python
import torch

def _softmax(x, axis=-1):
    return torch.softmax(x, dim=axis)
def _gelu(x):
    return torch.nn.functional.gelu(x, approximate="tanh")
def _silu(x):
    return torch.nn.functional.silu(x)
def _sigmoid(x):
    return torch.sigmoid(x)
def _layernorm(x, axis=-1, eps=1e-5):
    m = x.mean(dim=axis, keepdim=True)
    v = x.var(dim=axis, keepdim=True, unbiased=False)
    return (x - m) / torch.sqrt(v + eps)
def _scatter_add(tgt, idx, src, axis=0):
    return tgt.clone().index_add_(axis, idx, src)
def _segment_sum(src, seg, n):
    out = torch.zeros((n,) + src.shape[1:], dtype=src.dtype)
    return out.index_add_(0, seg, src)
def _pad(x, pw):
    flat = tuple(v for pair in reversed(pw) for v in pair)
    return torch.nn.functional.pad(x, flat)

kernel_name = 'gated_mix__linear_attn_block__dense_activation_squared_relu__prompt'

def setup_inputs():

    _w = (lambda a: (lambda t: t.to(torch.bfloat16) if t.is_floating_point() else t)(torch.as_tensor(a)))
    def _A_setup():
        B, S, D = 1, 2048, 512
        return {
            "x": _w((lambda *s: torch.randn(*s, dtype=torch.bfloat16) * 0.05)(B, S, D)),
            "wqkv": _w((lambda *s: torch.randn(*s, dtype=torch.bfloat16) * 0.8)(D, 3 * D)),
            "wo": _w((lambda *s: torch.randn(*s, dtype=torch.bfloat16) * 0.2)(D, D)),
        }
    _A_in = _A_setup()

    def _B_setup():
        B, S, D, F = 1, 2048, 512, 1792
        return {
            "x": _w((lambda *s: torch.randn(*s, dtype=torch.bfloat16) * 0.05)(B, S, D)),
            "w1": _w((lambda *s: torch.randn(*s, dtype=torch.bfloat16) * 0.1)(D, F)),
            "b1": _w((lambda *s: torch.randn(*s, dtype=torch.bfloat16) * 0.05)(F)),
            "w2": _w((lambda *s: torch.randn(*s, dtype=torch.bfloat16) * 0.05)(F, D)),
            "b2": _w((lambda *s: torch.randn(*s, dtype=torch.bfloat16) * 0.05)(D)),
        }
    _B_in = _B_setup()

    return {
        "A_x": _A_in["x"],
        "A_wqkv": _A_in["wqkv"],
        "A_wo": _A_in["wo"],
        "B_x": _B_in["x"],
        "B_w1": _B_in["w1"],
        "B_b1": _B_in["b1"],
        "B_w2": _B_in["w2"],
        "B_b2": _B_in["b2"],
        "gate_w": _w((lambda *s: torch.randn(*s, dtype=torch.bfloat16) * 0.05)(512) * 16.0),
    }

def reference(A_x, A_wqkv, A_wo, B_x, B_w1, B_b1, B_w2, B_b2, gate_w):
    def _A_ref(x, wqkv, wo):
        B, S, D = x.shape
        H = 32; Dh = D // H
        qkv = (lambda x, *d: x.permute(*d))((x @ wqkv).reshape(B, S, 3, H, Dh), 2, 0, 3, 1, 4)
        q, k, v = qkv[0], qkv[1], qkv[2]
        phi = lambda t: torch.where(t > 0, t + 1, torch.exp(t)) + 1e-6
        pq, pk = phi(q), phi(k)
        kv = torch.einsum("bhsd,bhse->bhde", pk, v)
        z = torch.einsum("bhsd->bhd", pk)
        num = torch.einsum("bhqd,bhde->bhqe", pq, kv)
        den = torch.einsum("bhqd,bhd->bhq", pq, z)[..., None] + 1e-6
        o = num / den
        return (lambda x, *d: x.permute(*d))(o, 0, 2, 1, 3).reshape(B, S, D) @ wo

    def _B_ref(x, w1, b1, w2, b2):
        h = torch.einsum("bsd,df->bsf", x, w1) + b1
        zero = torch.zeros_like(h)
        r = torch.where(h > zero, h, zero)
        h = r * r
        out = torch.einsum("bsf,fd->bsd", h, w2) + b2
        return out

    x = A_x
    g = _sigmoid((x * gate_w).sum(-1, keepdims=True))
    a = _A_ref(x, A_wqkv, A_wo)
    b = _B_ref(x, B_w1, B_b1, B_w2, B_b2)
    return g * a + (1 - g) * b
```

```asm
; @launch grid=(256,1,1) block=(512,1,1) lds=163840
.amdgcn_target "amdgcn-amd-amdhsa--gfx950"
.text
.globl gated_mix__linear_attn_block__dense_activation_squared_relu__prompt_kernel
.p2align 8
.type gated_mix__linear_attn_block__dense_activation_squared_relu__prompt_kernel,@function
gated_mix__linear_attn_block__dense_activation_squared_relu__prompt_kernel:
    s_cmp_ge_u32 s2, 256
    s_cbranch_scc1 L_end
    s_load_dwordx16 s[16:31], s[0:1], 0
    s_load_dwordx8 s[32:39], s[0:1], 64
    v_lshrrev_b32 v29, 6, v0
    v_and_b32 v1, 63, v0
    v_readfirstlane_b32 s3, v29
    s_bfe_u32 s13, s2, 0x20001
    s_bfe_u32 s14, s2, 0x20005
    s_bfe_u32 s7, s2, 0x20003
    s_lshr_b32 s15, s2, 7
    v_lshrrev_b32 v29, 3, v1
    s_lshl2_add_u32 s5, s13, s14
    s_lshl2_add_u32 s6, s15, s7
    s_xor_b32 s6, s6, 1
    v_and_b32 v30, 7, v1
    s_and_b32 s4, s2, 1
    s_lshl1_add_u32 s9, s14, s6
    v_lshrrev_b32 v3, 4, v1
    s_lshl3_add_u32 s13, s5, s3
    s_and_b32 s9, s9, 7
    v_xor_b32 v31, v30, v3
    s_lshl_b32 s13, s13, 14
    s_lshl_b32 s69, s9, 7
    v_lshlrev_b32 v31, 4, v31
    s_add_u32 s13, s13, 4096
    s_lshl_b32 s68, s3, 12
    v_lshl_add_u32 v31, v29, 10, v31
    s_and_b32 s11, s3, 1
    s_lshl2_add_u32 s70, s4, s7
    v_add_u32 v17, s13, v31
    s_lshr_b32 s10, s3, 1
    s_lshr_b32 s13, s70, 1
    v_xor_b32 v18, 64, v17
    s_and_b32 s8, s7, 1
    s_mul_i32 s71, s13, 7
    v_add_u32 v18, 7168, v18
    s_xor_b32 s87, s3, s8
    v_and_b32 v24, 2, v29
    s_lshl_b32 s13, s11, 2
    v_xor_b32 v24, v30, v24
    s_lshl_b32 s14, s3, 3
    v_xor_b32 v24, s13, v24
    s_mov_b32 s42, 0x201000
    s_mov_b32 s43, 0x20000
    v_lshlrev_b32 v24, 4, v24
    s_mov_b32 s46, 0x181000
    s_mov_b32 s47, 0x20000
    v_add_u32 v25, s14, v29
    s_mov_b32 s50, 0x1c1000
    s_mov_b32 s51, 0x20000
    v_lshlrev_b32 v2, 4, v1
    s_add_u32 m0, s68, 0
    s_lshl_b32 s78, s70, 7
    s_add_u32 s14, s71, s8
    s_add_u32 s13, s78, 1024
    s_add_u32 s79, s14, s8
    s_lshl_b32 s14, s14, 7
    s_lshl_b32 s79, s79, 7
    s_add_u32 s79, s79, 256
    s_cmp_ge_u32 s2, 128
    s_cselect_b32 s13, s79, s13
    s_cselect_b32 s86, s79, s14
    s_cselect_b32 s14, s78, s14
    s_movk_i32 s79, 3072
    s_cselect_b32 s79, 3584, s79
    s_cselect_b32 s99, -896, 0
    s_mov_b32 s54, 0x181000
    s_cselect_b32 s54, 0x1c1000, s54
    s_mov_b32 s55, 0x20000
    v_mul_u32_u24 v26, s79, v25
    s_add_u32 s15, s13, 2048
    s_lshr_b32 s79, s79, 1
    v_add3_u32 v19, v26, v24, s15
    s_mul_i32 s78, s69, s79
    v_add_u32 v20, s99, v19
    s_lshl_b32 s15, s11, 6
    s_add_u32 s86, s15, s86
    v_lshl_add_u32 v26, v3, 3, s86
    s_cmp_ge_u32 s2, 128
    s_cbranch_scc1 L_roleQ
    s_waitcnt lgkmcnt(0)
    s_sub_u32 s40, s16, 4096
    s_subb_u32 s41, s17, 0
    buffer_load_dwordx4 v17, s[40:43], s69 offen offset:0  lds
    buffer_load_dwordx4 v18, s[40:43], s69 offen offset:1024  lds
    s_sub_u32 s44, s18, 4096
    s_subb_u32 s45, s19, 0
    s_sub_u32 s48, s24, 4096
    s_subb_u32 s49, s25, 0
    s_cmp_ge_u32 s2, 128
    s_cselect_b64 s[52:53], s[48:49], s[44:45]
    buffer_load_dwordx4 v19, s[52:55], s78 offen offset:2048  lds
    buffer_load_dwordx4 v20, s[52:55], s78 offen offset:3072  lds
    global_load_dwordx2 v[88:89], v26, s[26:27] offset:0
    global_load_dwordx2 v[90:91], v26, s[26:27] offset:32
    s_getpc_b64 s[74:75]
    s_bfe_u32 s15, s2, 0x40003
    s_lshl_b32 s15, s15, 10
    v_lshl_add_u32 v26, v1, 7, s15
    s_mov_b32 m0, 133120
    s_cmp_eq_u32 s3, 6
    s_cselect_b64 exec, 0xff, 0
    global_load_lds_dword v26, s[74:75]
    s_mov_b64 exec, -1
    s_or_b32 s15, s2, s3
    s_cmp_eq_u32 s15, 0
    s_cselect_b64 exec, 1, 0
    global_load_dword v28, v2, s[38:39] sc0 sc1
    s_mov_b64 exec, -1
    s_lshl_b32 s15, s11, 6
    s_add_u32 s79, s71, 6
    s_lshl_b32 s79, s79, 7
    s_add_u32 s86, s15, s79
    v_lshl_add_u32 v82, v3, 3, s86
    s_sub_u32 s52, s28, 4096
    s_subb_u32 s53, s29, 0
    s_sub_u32 s56, s20, 4096
    s_subb_u32 s57, s21, 0
    s_mov_b64 s[60:61], s[38:39]
    s_mov_b32 s54, 0x1c1000
    s_mov_b32 s55, 0x20000
    s_mov_b32 s58, 0x81000
    s_mov_b32 s59, 0x20000
    s_mov_b32 s62, 0x10000000
    s_mov_b32 s63, 0x20000
    v_mul_u32_u24 v26, 3584, v25
    v_add3_u32 v21, v26, v24, s14
    v_add3_u32 v22, v26, v24, s79
    s_lshl1_add_u32 s13, s5, s4
    v_lshlrev_b32 v27, 2, v1
    s_lshl_b32 s24, s13, 9
    s_lshl_b32 s15, s7, 5
    s_add_u32 s24, s24, 0x20000
    s_add_u32 s15, s15, s3
    s_add_u32 s84, s24, 0x10000
    s_lshl2_add_u32 s85, s15, s84
    s_lshr_b32 s15, s3, 2
    s_lshl_b32 s15, s15, 8
    s_add_u32 s84, s84, s15
    s_lshl2_add_u32 s99, s13, s10
    s_lshl2_add_u32 s99, s99, s11
    s_lshl_b32 s99, s99, 8
    s_add_u32 s99, s99, 0x40000
    s_lshl_b32 s13, s11, 1
    s_and_b32 s15, s3, 2
    s_lshl_b32 s18, 0x330000, s13
    s_lshl4_add_u32 s15, s15, s13
    s_mov_b32 s19, s18
    s_lshl_b64 s[16:17], 0x33, s15
    s_lshl_b64 s[20:21], s[16:17], 24
    s_or_b64 s[20:21], s[20:21], s[18:19]
    s_lshl_b64 s[18:19], s[16:17], 8
    s_mov_b64 s[64:65], s[34:35]
    s_mov_b32 s66, 0x200000
    s_mov_b32 s67, 0x20000
    v_mul_u32_u24 v80, 3584, v1
    s_lshl_b32 s13, s6, 7
    s_add_u32 s13, s13, 4096
    v_lshl_add_u32 v81, v1, 10, s13
    s_mul_i32 s13, s5, 114688
    s_add_u32 s13, s13, 4096
    s_add_u32 s34, s13, s14
    s_mul_i32 s15, s8, 57344
    s_add_u32 s15, s15, s13
    s_add_u32 s35, s15, s79
    v_and_b32 v24, 15, v1
    v_lshrrev_b32 v25, 1, v24
    v_xor_b32 v25, v25, v3
    v_lshlrev_b32 v25, 4, v25
    s_lshl_b32 s13, s87, 12
    v_lshl_add_u32 v25, v24, 7, v25
    v_add_u32 v4, s13, v25
    v_xor_b32 v5, 64, v4
    v_xor_b32 v6, 0x1000, v4
    v_xor_b32 v7, 0x1000, v5
    v_add_u32 v8, 0x10000, v4
    v_add_u32 v9, 0x10000, v5
    v_add_u32 v10, 0x10000, v6
    v_add_u32 v11, 0x10000, v7
    v_bfe_u32 v24, v1, 2, 2
    v_and_b32 v25, 3, v29
    v_and_b32 v26, 3, v1
    v_lshlrev_b32 v26, 3, v26
    v_lshl_add_u32 v31, v25, 5, v26
    v_lshl_add_u32 v26, v24, 7, v31
    v_lshl_add_u32 v26, v3, 12, v26
    s_lshl_b32 s13, s11, 6
    v_xor_b32 v12, s13, v26
    v_xor_b32 v13, 32, v12
    v_add_u32 v14, 0x10000, v12
    v_add_u32 v15, 0x10000, v13
    s_mov_b32 s23, 0x358637bd
    s_mov_b32 s22, 0x3fb8aa3b
    v_mov_b32 v26, 0xb5c1a2a0
    v_lshlrev_b32 v24, 1, v3
    s_lshl_b32 s13, s11, 14
    v_xor_b32 v24, v30, v24
    s_lshl_b32 s14, s6, 7
    v_lshlrev_b32 v24, 4, v24
    s_add_u32 s13, s13, s14
    v_lshl_add_u32 v24, v29, 10, v24
    v_add_u32 v23, s13, v24
    s_lshl2_add_u32 s15, s4, s10
    s_and_b32 s14, s10, 1
    s_lshr_b32 s13, s15, 1
    s_lshl_b32 s77, s15, 16
    s_mul_i32 s13, s13, 7
    s_add_u32 s15, s13, s14
    s_lshl_b32 s75, s15, 16
    s_add_u32 s15, s15, s14
    s_lshl_b32 s74, s15, 16
    s_lshl1_add_u32 s13, s13, s14
    s_lshl_b32 s76, s13, 15
    s_lshl4_add_u32 s13, s4, s5
    s_lshl_b32 s13, s13, 3
    s_add_u32 s14, s13, s87
    s_xor_b32 s15, s14, 1
    s_mul_i32 s72, s14, 36864
    s_mul_i32 s73, s15, 36864
    s_mul_i32 s14, s7, 9
    s_add_u32 s14, s14, s11
    s_lshl_b32 s14, s14, 10
    s_add_u32 s14, s14, 0x400000
    s_add_u32 s72, s72, s14
    s_add_u32 s73, s73, s14
    s_lshl1_add_u32 s13, s11, s13
    s_lshl2_add_u32 s13, s4, s13
    s_xor_b32 s14, s13, 4
    s_mul_i32 s15, s10, 9216
    s_add_u32 s15, s15, 0x400000
    s_mul_i32 s14, s14, 36864
    s_mul_i32 s13, s13, 36864
    s_add_u32 s80, s14, s15
    s_add_u32 s82, s13, s15
    s_add_u32 s81, s80, 36864
    s_add_u32 s83, s82, 36864
    s_lshl3_add_u32 s98, s2, s3
    s_lshl_b32 s98, s98, 12
    s_add_u32 s98, s98, 0x1000000
    v_mov_b32 v30, 0
    v_mov_b32 v112, s23
    v_mov_b32 v113, s23
    v_mov_b32 v114, s23
    v_mov_b32 v115, s23
    s_or_b32 s13, s2, s3
    s_cmp_lg_u32 s13, 0
    s_cbranch_scc1 L_noep1
    s_waitcnt vmcnt(0)
    v_add_u32 v24, 1, v28
    v_or_b32 v24, 1, v24
    s_mov_b64 exec, 1
    global_store_dword v2, v24, s[36:37] sc1
    global_store_dword v2, v24, s[38:39] sc1
    s_mov_b64 exec, -1
L_noep1:
    s_add_u32 m0, s68, 32768
    s_add_u32 s69, s69, 128
    s_and_b32 s69, s69, 0x3ff
    buffer_load_dwordx4 v17, s[40:43], s69 offen offset:0  lds
    buffer_load_dwordx4 v18, s[40:43], s69 offen offset:1024  lds
    s_mul_i32 s78, s69, 1536
    buffer_load_dwordx4 v19, s[44:47], s78 offen offset:2048  lds
    buffer_load_dwordx4 v20, s[44:47], s78 offen offset:3072  lds
    global_load_dwordx2 v[92:93], v82, s[26:27] offset:0
    global_load_dwordx2 v[94:95], v82, s[26:27] offset:32
    s_waitcnt vmcnt(10)
    s_barrier
    ds_read_b128 v[128:131], v4 offset:0
    ds_read_b64_tr_b16 v[96:97], v12 offset:2048
    ds_read_b64_tr_b16 v[98:99], v12 offset:2560
    ds_read_b128 v[132:135], v6 offset:0
    ds_read_b64_tr_b16 v[100:101], v13 offset:2048
    ds_read_b64_tr_b16 v[102:103], v13 offset:2560
    ds_read_b64_tr_b16 v[104:105], v12 offset:3072
    ds_read_b64_tr_b16 v[106:107], v12 offset:3584
    ds_read_b64_tr_b16 v[108:109], v13 offset:3072
    ds_read_b64_tr_b16 v[110:111], v13 offset:3584
    s_add_u32 m0, s68, 65536
    s_add_u32 s69, s69, 128
    s_and_b32 s69, s69, 0x3ff
    buffer_load_dwordx4 v17, s[40:43], s69 offen offset:0  lds
    buffer_load_dwordx4 v18, s[40:43], s69 offen offset:1024  lds
    s_waitcnt lgkmcnt(0)
    v_mfma_f32_16x16x32_bf16 v[32:35], v[128:131], v[96:99], v[112:115]
    v_mfma_f32_16x16x32_bf16 v[36:39], v[132:135], v[96:99], v[112:115]
    v_mfma_f32_16x16x32_bf16 v[40:43], v[128:131], v[100:103], v[112:115]
    s_mul_i32 s78, s69, 1536
    buffer_load_dwordx4 v19, s[44:47], s78 offen offset:2048  lds
    v_mfma_f32_16x16x32_bf16 v[44:47], v[132:135], v[100:103], v[112:115]
    ds_read_b128 v[136:139], v5 offset:0
    ds_read_b64_tr_b16 v[112:113], v12 offset:18432
    ds_read_b64_tr_b16 v[114:115], v12 offset:18944
    v_mfma_f32_16x16x32_bf16 v[48:51], v[128:131], v[104:107], 0
    ds_read_b128 v[140:143], v7 offset:0
    ds_read_b64_tr_b16 v[116:117], v13 offset:18432
    ds_read_b64_tr_b16 v[118:119], v13 offset:18944
    v_mfma_f32_16x16x32_bf16 v[52:55], v[132:135], v[104:107], 0
    ds_read_b64_tr_b16 v[120:121], v12 offset:19456
    ds_read_b64_tr_b16 v[122:123], v12 offset:19968
    ds_read_b64_tr_b16 v[124:125], v13 offset:19456
    buffer_load_dwordx4 v20, s[44:47], s78 offen offset:3072  lds
    v_mfma_f32_16x16x32_bf16 v[56:59], v[128:131], v[108:111], 0
    ds_read_b64_tr_b16 v[126:127], v13 offset:19968
    v_mfma_f32_16x16x32_bf16 v[60:63], v[132:135], v[108:111], 0
    s_waitcnt vmcnt(6) lgkmcnt(0)
    s_barrier
    ds_read_b128 v[144:147], v4 offset:32768
    ds_read_b64_tr_b16 v[96:97], v12 offset:34816
    v_mfma_f32_16x16x32_bf16 v[32:35], v[136:139], v[112:115], v[32:35]
    ds_read_b64_tr_b16 v[98:99], v12 offset:35328
    ds_read_b128 v[148:151], v6 offset:32768
    v_lshlrev_b32 v64, 16, v88
    s_add_u32 m0, s68, 98304
    s_add_u32 s69, s69, 128
    s_and_b32 s69, s69, 0x3ff
    buffer_load_dwordx4 v17, s[40:43], s69 offen offset:0  lds
    v_mfma_f32_16x16x32_bf16 v[36:39], v[140:143], v[112:115], v[36:39]
    ds_read_b64_tr_b16 v[100:101], v13 offset:34816
    ds_read_b64_tr_b16 v[102:103], v13 offset:35328
    v_and_b32 v65, 0xffff0000, v88
    v_mfma_f32_16x16x32_bf16 v[40:43], v[136:139], v[116:119], v[40:43]
    ds_read_b64_tr_b16 v[104:105], v12 offset:35840
    ds_read_b64_tr_b16 v[106:107], v12 offset:36352
    v_lshlrev_b32 v66, 16, v89
    v_mfma_f32_16x16x32_bf16 v[44:47], v[140:143], v[116:119], v[44:47]
    ds_read_b64_tr_b16 v[108:109], v13 offset:35840
    ds_read_b64_tr_b16 v[110:111], v13 offset:36352
    v_and_b32 v67, 0xffff0000, v89
    buffer_load_dwordx4 v18, s[40:43], s69 offen offset:1024  lds
    v_mfma_f32_16x16x32_bf16 v[48:51], v[136:139], v[120:123], v[48:51]
    v_lshlrev_b32 v68, 16, v88
    v_mfma_f32_16x16x32_bf16 v[52:55], v[140:143], v[120:123], v[52:55]
    v_and_b32 v69, 0xffff0000, v88
    v_mfma_f32_16x16x32_bf16 v[56:59], v[136:139], v[124:127], v[56:59]
    v_lshlrev_b32 v70, 16, v89
    s_mul_i32 s78, s69, 1536
    buffer_load_dwordx4 v19, s[44:47], s78 offen offset:2048  lds
    v_mfma_f32_16x16x32_bf16 v[60:63], v[140:143], v[124:127], v[60:63]
    v_and_b32 v71, 0xffff0000, v89
    s_waitcnt lgkmcnt(0)
    ds_read_b128 v[152:155], v5 offset:32768
    ds_read_b64_tr_b16 v[112:113], v12 offset:51200
    v_mfma_f32_16x16x32_bf16 v[32:35], v[144:147], v[96:99], v[32:35]
    ds_read_b64_tr_b16 v[114:115], v12 offset:51712
    ds_read_b128 v[156:159], v7 offset:32768
    v_lshlrev_b32 v72, 16, v90
    v_mfma_f32_16x16x32_bf16 v[36:39], v[148:151], v[96:99], v[36:39]
    ds_read_b64_tr_b16 v[116:117], v13 offset:51200
    ds_read_b64_tr_b16 v[118:119], v13 offset:51712
    v_and_b32 v73, 0xffff0000, v90
    buffer_load_dwordx4 v20, s[44:47], s78 offen offset:3072  lds
    v_mfma_f32_16x16x32_bf16 v[40:43], v[144:147], v[100:103], v[40:43]
    ds_read_b64_tr_b16 v[120:121], v12 offset:52224
    ds_read_b64_tr_b16 v[122:123], v12 offset:52736
    v_lshlrev_b32 v74, 16, v91
    v_mfma_f32_16x16x32_bf16 v[44:47], v[148:151], v[100:103], v[44:47]
    ds_read_b64_tr_b16 v[124:125], v13 offset:52224
    ds_read_b64_tr_b16 v[126:127], v13 offset:52736
    v_and_b32 v75, 0xffff0000, v91
    v_mfma_f32_16x16x32_bf16 v[48:51], v[144:147], v[104:107], v[48:51]
    v_lshlrev_b32 v76, 16, v90
    s_add_u32 m0, s68, 0
    s_add_u32 s69, s69, 128
    s_and_b32 s69, s69, 0x3ff
    buffer_load_dwordx4 v17, s[40:43], s69 offen offset:0  lds
    v_mfma_f32_16x16x32_bf16 v[52:55], v[148:151], v[104:107], v[52:55]
    v_and_b32 v77, 0xffff0000, v90
    v_mfma_f32_16x16x32_bf16 v[56:59], v[144:147], v[108:111], v[56:59]
    v_lshlrev_b32 v78, 16, v91
    v_mfma_f32_16x16x32_bf16 v[60:63], v[148:151], v[108:111], v[60:63]
    v_and_b32 v79, 0xffff0000, v91
    buffer_load_dwordx4 v18, s[40:43], s69 offen offset:1024  lds
    s_waitcnt vmcnt(6) lgkmcnt(0)
    s_barrier
    ds_read_b128 v[160:163], v8 offset:0
    ds_read_b64_tr_b16 v[96:97], v14 offset:2048
    v_mfma_f32_16x16x32_bf16 v[32:35], v[152:155], v[112:115], v[32:35]
    ds_read_b64_tr_b16 v[98:99], v14 offset:2560
    ds_read_b128 v[164:167], v10 offset:0
    v_mfma_f32_16x16x32_bf16 v[36:39], v[156:159], v[112:115], v[36:39]
    ds_read_b64_tr_b16 v[100:101], v15 offset:2048
    ds_read_b64_tr_b16 v[102:103], v15 offset:2560
    v_mfma_f32_16x16x32_bf16 v[40:43], v[152:155], v[116:119], v[40:43]
    ds_read_b64_tr_b16 v[104:105], v14 offset:3072
    ds_read_b64_tr_b16 v[106:107], v14 offset:3584
    s_mul_i32 s78, s69, 1536
    buffer_load_dwordx4 v19, s[44:47], s78 offen offset:2048  lds
    v_mfma_f32_16x16x32_bf16 v[44:47], v[156:159], v[116:119], v[44:47]
    ds_read_b64_tr_b16 v[108:109], v15 offset:3072
    ds_read_b64_tr_b16 v[110:111], v15 offset:3584
    v_mfma_f32_16x16x32_bf16 v[48:51], v[152:155], v[120:123], v[48:51]
    v_mfma_f32_16x16x32_bf16 v[52:55], v[156:159], v[120:123], v[52:55]
    buffer_load_dwordx4 v20, s[44:47], s78 offen offset:3072  lds
    v_mfma_f32_16x16x32_bf16 v[56:59], v[152:155], v[124:127], v[56:59]
    v_mfma_f32_16x16x32_bf16 v[60:63], v[156:159], v[124:127], v[60:63]
    s_waitcnt lgkmcnt(0)
    ds_read_b128 v[168:171], v9 offset:0
    ds_read_b64_tr_b16 v[112:113], v14 offset:18432
    v_mfma_f32_16x16x32_bf16 v[32:35], v[160:163], v[96:99], v[32:35]
    ds_read_b64_tr_b16 v[114:115], v14 offset:18944
    ds_read_b128 v[172:175], v11 offset:0
    s_add_u32 m0, s68, 32768
    s_add_u32 s69, s69, 128
    s_and_b32 s69, s69, 0x3ff
    buffer_load_dwordx4 v17, s[40:43], s69 offen offset:0  lds
    v_mfma_f32_16x16x32_bf16 v[36:39], v[164:167], v[96:99], v[36:39]
    ds_read_b64_tr_b16 v[116:117], v15 offset:18432
    ds_read_b64_tr_b16 v[118:119], v15 offset:18944
    v_mfma_f32_16x16x32_bf16 v[40:43], v[160:163], v[100:103], v[40:43]
    ds_read_b64_tr_b16 v[120:121], v14 offset:19456
    ds_read_b64_tr_b16 v[122:123], v14 offset:19968
    v_mfma_f32_16x16x32_bf16 v[44:47], v[164:167], v[100:103], v[44:47]
    ds_read_b64_tr_b16 v[124:125], v15 offset:19456
    ds_read_b64_tr_b16 v[126:127], v15 offset:19968
    buffer_load_dwordx4 v18, s[40:43], s69 offen offset:1024  lds
    v_mfma_f32_16x16x32_bf16 v[48:51], v[160:163], v[104:107], v[48:51]
    v_mfma_f32_16x16x32_bf16 v[52:55], v[164:167], v[104:107], v[52:55]
    v_mfma_f32_16x16x32_bf16 v[56:59], v[160:163], v[108:111], v[56:59]
    s_mul_i32 s78, s69, 1536
    buffer_load_dwordx4 v19, s[44:47], s78 offen offset:2048  lds
    v_mfma_f32_16x16x32_bf16 v[60:63], v[164:167], v[108:111], v[60:63]
    s_waitcnt vmcnt(7) lgkmcnt(0)
    s_barrier
    ds_read_b128 v[176:179], v8 offset:32768
    ds_read_b64_tr_b16 v[96:97], v14 offset:34816
    v_mfma_f32_16x16x32_bf16 v[32:35], v[168:171], v[112:115], v[32:35]
    ds_read_b64_tr_b16 v[98:99], v14 offset:35328
    ds_read_b128 v[180:183], v10 offset:32768
    v_mfma_f32_16x16x32_bf16 v[36:39], v[172:175], v[112:115], v[36:39]
    ds_read_b64_tr_b16 v[100:101], v15 offset:34816
    ds_read_b64_tr_b16 v[102:103], v15 offset:35328
    buffer_load_dwordx4 v20, s[44:47], s78 offen offset:3072  lds
    v_mfma_f32_16x16x32_bf16 v[40:43], v[168:171], v[116:119], v[40:43]
    ds_read_b64_tr_b16 v[104:105], v14 offset:35840
    ds_read_b64_tr_b16 v[106:107], v14 offset:36352
    v_mfma_f32_16x16x32_bf16 v[44:47], v[172:175], v[116:119], v[44:47]
    ds_read_b64_tr_b16 v[108:109], v15 offset:35840
    ds_read_b64_tr_b16 v[110:111], v15 offset:36352
    v_mfma_f32_16x16x32_bf16 v[48:51], v[168:171], v[120:123], v[48:51]
    s_mov_b32 m0, 133120
    s_cmp_eq_u32 s3, 1
    s_cselect_b32 exec_lo, -1, 0
    s_cselect_b32 exec_hi, 0, 0
    buffer_load_dword v80, s[48:51], s34 offen offset:0 lds
    s_mov_b64 exec, -1
    v_mfma_f32_16x16x32_bf16 v[52:55], v[172:175], v[120:123], v[52:55]
    v_mfma_f32_16x16x32_bf16 v[56:59], v[168:171], v[124:127], v[56:59]
    v_mfma_f32_16x16x32_bf16 v[60:63], v[172:175], v[124:127], v[60:63]
    s_mov_b32 m0, 133120
    s_cmp_eq_u32 s3, 2
    s_cselect_b32 exec_lo, 0xffff, 0
    s_cselect_b32 exec_hi, 0, 0
    buffer_load_dword v80, s[48:51], s35 offen offset:0 lds
    s_mov_b64 exec, -1
    s_waitcnt lgkmcnt(0)
    ds_read_b128 v[184:187], v9 offset:32768
    ds_read_b64_tr_b16 v[112:113], v14 offset:51200
    v_mfma_f32_16x16x32_bf16 v[32:35], v[176:179], v[96:99], v[32:35]
    ds_read_b64_tr_b16 v[114:115], v14 offset:51712
    ds_read_b128 v[188:191], v11 offset:32768
    v_mfma_f32_16x16x32_bf16 v[36:39], v[180:183], v[96:99], v[36:39]
    ds_read_b64_tr_b16 v[116:117], v15 offset:51200
    ds_read_b64_tr_b16 v[118:119], v15 offset:51712
    v_mfma_f32_16x16x32_bf16 v[40:43], v[176:179], v[100:103], v[40:43]
    ds_read_b64_tr_b16 v[120:121], v14 offset:52224
    ds_read_b64_tr_b16 v[122:123], v14 offset:52736
    s_lshl4_add_u32 s34, s4, s5
    s_mul_i32 s35, s34, 57344
    s_mov_b32 m0, 133120
    s_cmp_eq_u32 s3, 3
    s_cselect_b32 exec_lo, -1, 0
    s_cselect_b32 exec_hi, 0xffffff, 0
    buffer_load_dword v81, s[52:55], s35 offen offset:0 lds
    s_mov_b64 exec, -1
    v_mfma_f32_16x16x32_bf16 v[44:47], v[180:183], v[100:103], v[44:47]
    ds_read_b64_tr_b16 v[124:125], v15 offset:52224
    ds_read_b64_tr_b16 v[126:127], v15 offset:52736
    v_mfma_f32_16x16x32_bf16 v[48:51], v[176:179], v[104:107], v[48:51]
    v_mfma_f32_16x16x32_bf16 v[52:55], v[180:183], v[104:107], v[52:55]
    s_lshl_b32 s35, s34, 14
    s_mov_b32 m0, 133120
    s_cmp_eq_u32 s3, 4
    s_cselect_b32 exec_lo, 0xffff, 0
    s_cselect_b32 exec_hi, 0, 0
    buffer_load_dword v81, s[56:59], s35 offen offset:0 lds
    s_mov_b64 exec, -1
    v_mfma_f32_16x16x32_bf16 v[56:59], v[176:179], v[108:111], v[56:59]
    v_mfma_f32_16x16x32_bf16 v[60:63], v[180:183], v[108:111], v[60:63]
    s_waitcnt vmcnt(8) lgkmcnt(0)
    s_barrier
    ds_read_b128 v[192:195], v4 offset:0
    ds_read_b64_tr_b16 v[96:97], v12 offset:2048
    v_mfma_f32_16x16x32_bf16 v[32:35], v[184:187], v[112:115], v[32:35]
    ds_read_b64_tr_b16 v[98:99], v12 offset:2560
    ds_read_b128 v[196:199], v6 offset:0
    s_mov_b32 m0, 133120
    s_cmp_eq_u32 s3, 5
    s_cselect_b32 exec_lo, 1, 0
    s_cselect_b32 exec_hi, 0, 0
    buffer_load_dword v27, s[60:63], s85 offen offset:0 lds
    s_mov_b64 exec, -1
    v_mfma_f32_16x16x32_bf16 v[36:39], v[188:191], v[112:115], v[36:39]
    ds_read_b64_tr_b16 v[100:101], v13 offset:2048
    ds_read_b64_tr_b16 v[102:103], v13 offset:2560
    v_mfma_f32_16x16x32_bf16 v[40:43], v[184:187], v[116:119], v[40:43]
    ds_read_b64_tr_b16 v[104:105], v12 offset:3072
    ds_read_b64_tr_b16 v[106:107], v12 offset:3584
    v_mfma_f32_16x16x32_bf16 v[44:47], v[188:191], v[116:119], v[44:47]
    ds_read_b64_tr_b16 v[108:109], v13 offset:3072
    ds_read_b64_tr_b16 v[110:111], v13 offset:3584
    s_add_u32 m0, s68, 65536
    s_add_u32 s69, s69, 128
    s_and_b32 s69, s69, 0x3ff
    buffer_load_dwordx4 v17, s[40:43], s69 offen offset:0  lds
    v_mfma_f32_16x16x32_bf16 v[48:51], v[184:187], v[120:123], v[48:51]
    v_mfma_f32_16x16x32_bf16 v[52:55], v[188:191], v[120:123], v[52:55]
    v_mfma_f32_16x16x32_bf16 v[56:59], v[184:187], v[124:127], v[56:59]
    buffer_load_dwordx4 v18, s[40:43], s69 offen offset:1024  lds
    v_mfma_f32_16x16x32_bf16 v[60:63], v[188:191], v[124:127], v[60:63]
    s_waitcnt lgkmcnt(0)
    ds_read_b128 v[200:203], v5 offset:0
    ds_read_b64_tr_b16 v[112:113], v12 offset:18432
    v_mfma_f32_16x16x32_bf16 v[32:35], v[192:195], v[96:99], v[32:35]
    ds_read_b64_tr_b16 v[114:115], v12 offset:18944
    ds_read_b128 v[204:207], v7 offset:0
    v_mfma_f32_16x16x32_bf16 v[36:39], v[196:199], v[96:99], v[36:39]
    ds_read_b64_tr_b16 v[116:117], v13 offset:18432
    ds_read_b64_tr_b16 v[118:119], v13 offset:18944
    s_mul_i32 s78, s69, 1536
    buffer_load_dwordx4 v19, s[44:47], s78 offen offset:2048  lds
    v_mfma_f32_16x16x32_bf16 v[40:43], v[192:195], v[100:103], v[40:43]
    ds_read_b64_tr_b16 v[120:121], v12 offset:19456
    ds_read_b64_tr_b16 v[122:123], v12 offset:19968
    v_mfma_f32_16x16x32_bf16 v[44:47], v[196:199], v[100:103], v[44:47]
    ds_read_b64_tr_b16 v[124:125], v13 offset:19456
    ds_read_b64_tr_b16 v[126:127], v13 offset:19968
    v_mfma_f32_16x16x32_bf16 v[48:51], v[192:195], v[104:107], v[48:51]
    buffer_load_dwordx4 v20, s[44:47], s78 offen offset:3072  lds
    v_mfma_f32_16x16x32_bf16 v[52:55], v[196:199], v[104:107], v[52:55]
    v_mfma_f32_16x16x32_bf16 v[56:59], v[192:195], v[108:111], v[56:59]
    v_mfma_f32_16x16x32_bf16 v[60:63], v[196:199], v[108:111], v[60:63]
    s_add_u32 m0, s68, 98304
    s_add_u32 s69, s69, 128
    s_and_b32 s69, s69, 0x3ff
    buffer_load_dwordx4 v17, s[40:43], s69 offen offset:0  lds
    s_waitcnt vmcnt(10) lgkmcnt(0)
    s_barrier
    ds_read_b128 v[208:211], v4 offset:32768
    ds_read_b64_tr_b16 v[96:97], v12 offset:34816
    v_mfma_f32_16x16x32_bf16 v[32:35], v[200:203], v[112:115], v[32:35]
    ds_read_b64_tr_b16 v[98:99], v12 offset:35328
    ds_read_b128 v[212:215], v6 offset:32768
    v_lshlrev_b32 v80, 16, v92
    v_mfma_f32_16x16x32_bf16 v[36:39], v[204:207], v[112:115], v[36:39]
    ds_read_b64_tr_b16 v[100:101], v13 offset:34816
    ds_read_b64_tr_b16 v[102:103], v13 offset:35328
    v_and_b32 v81, 0xffff0000, v92
    v_mfma_f32_16x16x32_bf16 v[40:43], v[200:203], v[116:119], v[40:43]
    ds_read_b64_tr_b16 v[104:105], v12 offset:35840
    ds_read_b64_tr_b16 v[106:107], v12 offset:36352
    v_lshlrev_b32 v82, 16, v93
    buffer_load_dwordx4 v18, s[40:43], s69 offen offset:1024  lds
    v_mfma_f32_16x16x32_bf16 v[44:47], v[204:207], v[116:119], v[44:47]
    ds_read_b64_tr_b16 v[108:109], v13 offset:35840
    ds_read_b64_tr_b16 v[110:111], v13 offset:36352
    v_and_b32 v83, 0xffff0000, v93
    v_mfma_f32_16x16x32_bf16 v[48:51], v[200:203], v[120:123], v[48:51]
    v_lshlrev_b32 v84, 16, v94
    v_mfma_f32_16x16x32_bf16 v[52:55], v[204:207], v[120:123], v[52:55]
    v_and_b32 v85, 0xffff0000, v94
    s_mul_i32 s78, s69, 1536
    buffer_load_dwordx4 v19, s[44:47], s78 offen offset:2048  lds
    v_mfma_f32_16x16x32_bf16 v[56:59], v[200:203], v[124:127], v[56:59]
    v_lshlrev_b32 v86, 16, v95
    v_mfma_f32_16x16x32_bf16 v[60:63], v[204:207], v[124:127], v[60:63]
    v_and_b32 v87, 0xffff0000, v95
    s_waitcnt lgkmcnt(0)
    ds_read_b128 v[216:219], v5 offset:32768
    ds_read_b64_tr_b16 v[112:113], v12 offset:51200
    v_mfma_f32_16x16x32_bf16 v[32:35], v[208:211], v[96:99], v[32:35]
    ds_read_b64_tr_b16 v[114:115], v12 offset:51712
    ds_read_b128 v[220:223], v7 offset:32768
    v_mov_b32 v92, 0x3f803f80
    buffer_load_dwordx4 v20, s[44:47], s78 offen offset:3072  lds
    v_mfma_f32_16x16x32_bf16 v[36:39], v[212:215], v[96:99], v[36:39]
    ds_read_b64_tr_b16 v[116:117], v13 offset:51200
    ds_read_b64_tr_b16 v[118:119], v13 offset:51712
    v_mov_b32 v93, 0x3f803f80
    v_mfma_f32_16x16x32_bf16 v[40:43], v[208:211], v[100:103], v[40:43]
    ds_read_b64_tr_b16 v[120:121], v12 offset:52224
    ds_read_b64_tr_b16 v[122:123], v12 offset:52736
    v_mov_b32 v94, 0x3f803f80
    v_mfma_f32_16x16x32_bf16 v[44:47], v[212:215], v[100:103], v[44:47]
    ds_read_b64_tr_b16 v[124:125], v13 offset:52224
    ds_read_b64_tr_b16 v[126:127], v13 offset:52736
    v_mov_b32 v95, 0x3f803f80
    global_load_dword v28, v30, s[36:37] sc1
    v_mfma_f32_16x16x32_bf16 v[48:51], v[208:211], v[104:107], v[48:51]
    s_lshl_b32 s13, s3, 11
    v_mfma_f32_16x16x32_bf16 v[52:55], v[212:215], v[104:107], v[52:55]
    s_add_u32 s13, s13, 98304
    v_mfma_f32_16x16x32_bf16 v[56:59], v[208:211], v[108:111], v[56:59]
    v_add_u32 v24, s13, v2
    s_add_u32 m0, s68, 0
    s_add_u32 s69, s69, 128
    s_and_b32 s69, s69, 0x3ff
    s_mul_i32 s78, s69, 1792
    s_add_u32 s78, s78, 4096
    buffer_load_dwordx4 v21, s[48:51], s78 offen offset:0  lds
    v_mfma_f32_16x16x32_bf16 v[60:63], v[212:215], v[108:111], v[60:63]
    s_lshl_b32 s13, s3, 7
    s_waitcnt vmcnt(6) lgkmcnt(0)
    s_barrier
    ds_read_b128 v[224:227], v8 offset:0
    ds_read_b64_tr_b16 v[96:97], v14 offset:2048
    v_mfma_f32_16x16x32_bf16 v[32:35], v[216:219], v[112:115], v[32:35]
    ds_read_b64_tr_b16 v[98:99], v14 offset:2560
    ds_read_b128 v[228:231], v10 offset:0
    s_add_u32 s13, s13, 114688
    v_mfma_f32_16x16x32_bf16 v[36:39], v[220:223], v[112:115], v[36:39]
    ds_read_b64_tr_b16 v[100:101], v15 offset:2048
    ds_read_b64_tr_b16 v[102:103], v15 offset:2560
    v_and_b32 v29, 15, v1
    s_add_u32 s69, s69, 128
    s_and_b32 s69, s69, 0x3ff
    s_mul_i32 s78, s69, 1792
    s_add_u32 s78, s78, 3072
    buffer_load_dwordx4 v21, s[48:51], s78 offen offset:1024  lds
    v_mfma_f32_16x16x32_bf16 v[40:43], v[216:219], v[116:119], v[40:43]
    ds_read_b64_tr_b16 v[104:105], v14 offset:3072
    ds_read_b64_tr_b16 v[106:107], v14 offset:3584
    v_lshl_add_u32 v25, v29, 2, s13
    v_mfma_f32_16x16x32_bf16 v[44:47], v[220:223], v[116:119], v[44:47]
    ds_read_b64_tr_b16 v[108:109], v15 offset:3072
    ds_read_b64_tr_b16 v[110:111], v15 offset:3584
    s_and_b32 s14, s3, 3
    v_mfma_f32_16x16x32_bf16 v[48:51], v[216:219], v[120:123], v[48:51]
    s_lshl_b32 s13, s14, 10
    s_add_u32 s69, s69, 128
    s_and_b32 s69, s69, 0x3ff
    s_mul_i32 s78, s69, 1792
    s_add_u32 s78, s78, 2048
    buffer_load_dwordx4 v21, s[48:51], s78 offen offset:2048  lds
    v_mfma_f32_16x16x32_bf16 v[52:55], v[220:223], v[120:123], v[52:55]
    s_add_u32 s13, s13, 98304
    v_mfma_f32_16x16x32_bf16 v[56:59], v[216:219], v[124:127], v[56:59]
    v_add_u32 v16, s13, v2
    v_mfma_f32_16x16x32_bf16 v[60:63], v[220:223], v[124:127], v[60:63]
    s_lshl_b32 s13, s14, 6
    s_add_u32 s69, s69, 128
    s_and_b32 s69, s69, 0x3ff
    s_mul_i32 s78, s69, 1792
    s_add_u32 s78, s78, 1024
    buffer_load_dwordx4 v21, s[48:51], s78 offen offset:3072  lds
    s_waitcnt lgkmcnt(0)
    ds_read_b128 v[232:235], v9 offset:0
    ds_read_b64_tr_b16 v[112:113], v14 offset:18432
    v_mfma_f32_16x16x32_bf16 v[32:35], v[224:227], v[96:99], v[32:35]
    ds_read_b64_tr_b16 v[114:115], v14 offset:18944
    ds_read_b128 v[236:239], v11 offset:0
    s_add_u32 s13, s13, 114688
    v_mfma_f32_16x16x32_bf16 v[36:39], v[228:231], v[96:99], v[36:39]
    ds_read_b64_tr_b16 v[116:117], v15 offset:18432
    ds_read_b64_tr_b16 v[118:119], v15 offset:18944
    v_lshl_add_u32 v29, v29, 2, s13
    v_mfma_f32_16x16x32_bf16 v[40:43], v[224:227], v[100:103], v[40:43]
    ds_read_b64_tr_b16 v[120:121], v14 offset:19456
    ds_read_b64_tr_b16 v[122:123], v14 offset:19968
    s_lshl4_add_u32 s13, s70, s5
    s_add_u32 m0, s68, 32768
    s_add_u32 s69, s69, 128
    s_and_b32 s69, s69, 0x3ff
    s_mul_i32 s78, s69, 1792
    s_add_u32 s78, s78, 4096
    buffer_load_dwordx4 v21, s[48:51], s78 offen offset:0  lds
    v_mfma_f32_16x16x32_bf16 v[44:47], v[228:231], v[100:103], v[44:47]
    ds_read_b64_tr_b16 v[124:125], v15 offset:19456
    ds_read_b64_tr_b16 v[126:127], v15 offset:19968
    s_lshl2_add_u32 s13, s13, s14
    v_mfma_f32_16x16x32_bf16 v[48:51], v[224:227], v[104:107], v[48:51]
    s_lshl_b32 s15, s13, 7
    v_mfma_f32_16x16x32_bf16 v[52:55], v[228:231], v[104:107], v[52:55]
    s_lshl_b32 s79, s13, 10
    s_add_u32 s69, s69, 128
    s_and_b32 s69, s69, 0x3ff
    s_mul_i32 s78, s69, 1792
    s_add_u32 s78, s78, 3072
    buffer_load_dwordx4 v21, s[48:51], s78 offen offset:1024  lds
    v_mfma_f32_16x16x32_bf16 v[56:59], v[224:227], v[108:111], v[56:59]
    s_lshl2_add_u32 s34, s13, 0x1000
    v_mfma_f32_16x16x32_bf16 v[60:63], v[228:231], v[108:111], v[60:63]
    s_add_u32 s15, s15, 0x180000
    s_waitcnt vmcnt(7) lgkmcnt(0)
    s_barrier
    ds_read_b128 v[240:243], v8 offset:32768
    ds_read_b64_tr_b16 v[96:97], v14 offset:34816
    v_mfma_f32_16x16x32_bf16 v[32:35], v[232:235], v[112:115], v[32:35]
    ds_read_b64_tr_b16 v[98:99], v14 offset:35328
    ds_read_b128 v[244:247], v10 offset:32768
    s_add_u32 s79, s79, 0x100000
    s_add_u32 s69, s69, 128
    s_and_b32 s69, s69, 0x3ff
    s_mul_i32 s78, s69, 1792
    s_add_u32 s78, s78, 2048
    buffer_load_dwordx4 v21, s[48:51], s78 offen offset:2048  lds
    v_mfma_f32_16x16x32_bf16 v[36:39], v[236:239], v[112:115], v[36:39]
    ds_read_b64_tr_b16 v[100:101], v15 offset:34816
    ds_read_b64_tr_b16 v[102:103], v15 offset:35328
    v_mfma_f32_16x16x32_bf16 v[40:43], v[232:235], v[116:119], v[40:43]
    ds_read_b64_tr_b16 v[104:105], v14 offset:35840
    ds_read_b64_tr_b16 v[106:107], v14 offset:36352
    v_mfma_f32_16x16x32_bf16 v[44:47], v[236:239], v[116:119], v[44:47]
    ds_read_b64_tr_b16 v[108:109], v15 offset:35840
    ds_read_b64_tr_b16 v[110:111], v15 offset:36352
    s_add_u32 s69, s69, 128
    s_and_b32 s69, s69, 0x3ff
    s_mul_i32 s78, s69, 1792
    s_add_u32 s78, s78, 1024
    buffer_load_dwordx4 v21, s[48:51], s78 offen offset:3072  lds
    v_mfma_f32_16x16x32_bf16 v[48:51], v[232:235], v[120:123], v[48:51]
    v_mfma_f32_16x16x32_bf16 v[52:55], v[236:239], v[120:123], v[52:55]
    v_mfma_f32_16x16x32_bf16 v[56:59], v[232:235], v[124:127], v[56:59]
    s_add_u32 m0, s68, 131072
    s_add_u32 s78, s74, 135168
    buffer_load_dwordx4 v23, s[52:55], s78 offen offset:0  lds
    v_mfma_f32_16x16x32_bf16 v[60:63], v[236:239], v[124:127], v[60:63]
    s_waitcnt lgkmcnt(0)
    ds_read_b128 v[248:251], v9 offset:32768
    ds_read_b64_tr_b16 v[112:113], v14 offset:51200
    v_mfma_f32_16x16x32_bf16 v[32:35], v[240:243], v[96:99], v[32:35]
    ds_read_b64_tr_b16 v[114:115], v14 offset:51712
    ds_read_b128 v[252:255], v11 offset:32768
    v_mfma_f32_16x16x32_bf16 v[36:39], v[244:247], v[96:99], v[36:39]
    ds_read_b64_tr_b16 v[116:117], v15 offset:51200
    ds_read_b64_tr_b16 v[118:119], v15 offset:51712
    s_add_u32 s78, s74, 142336
    buffer_load_dwordx4 v23, s[52:55], s78 offen offset:1024  lds
    v_mfma_f32_16x16x32_bf16 v[40:43], v[240:243], v[100:103], v[40:43]
    ds_read_b64_tr_b16 v[120:121], v14 offset:52224
    ds_read_b64_tr_b16 v[122:123], v14 offset:52736
    v_mfma_f32_16x16x32_bf16 v[44:47], v[244:247], v[100:103], v[44:47]
    ds_read_b64_tr_b16 v[124:125], v15 offset:52224
    ds_read_b64_tr_b16 v[126:127], v15 offset:52736
    v_mfma_f32_16x16x32_bf16 v[48:51], v[240:243], v[104:107], v[48:51]
    s_add_u32 s78, s74, 165888
    buffer_load_dwordx4 v23, s[52:55], s78 offen offset:2048  lds
    v_mfma_f32_16x16x32_bf16 v[52:55], v[244:247], v[104:107], v[52:55]
    v_mfma_f32_16x16x32_bf16 v[56:59], v[240:243], v[108:111], v[56:59]
    v_mfma_f32_16x16x32_bf16 v[60:63], v[244:247], v[108:111], v[60:63]
    s_add_u32 s78, s74, 173056
    buffer_load_dwordx4 v23, s[52:55], s78 offen offset:3072  lds
    s_waitcnt vmcnt(8) lgkmcnt(0)
    s_barrier
    v_readfirstlane_b32 s12, v28
    s_nop 0
    s_cmp_lg_u32 s12, 0
    s_cbranch_scc1 L_epok2
    s_mov_b32 s86, 0
L_eplp3:
    global_load_dword v28, v30, s[36:37] sc1
    s_waitcnt vmcnt(0)
    v_readfirstlane_b32 s12, v28
    s_add_u32 s86, s86, 1
    s_cmp_lg_u32 s12, 0
    s_cbranch_scc1 L_epok2
    s_cmp_lt_u32 s86, 0x100000
    s_cbranch_scc1 L_eplp3
L_epok2:
    v_mov_b32 v0, s12
    ds_read_b64_tr_b16 v[96:97], v12 offset:0
    ds_read_b64_tr_b16 v[98:99], v12 offset:512
    v_mfma_f32_16x16x32_bf16 v[32:35], v[248:251], v[112:115], v[32:35]
    ds_read_b64_tr_b16 v[100:101], v13 offset:0
    ds_read_b64_tr_b16 v[102:103], v13 offset:512
    v_mfma_f32_16x16x32_bf16 v[36:39], v[252:255], v[112:115], v[36:39]
    v_mfma_f32_16x16x32_bf16 v[40:43], v[248:251], v[116:119], v[40:43]
    s_add_u32 m0, s68, 65536
    s_add_u32 s69, s69, 128
    s_and_b32 s69, s69, 0x3ff
    s_mul_i32 s78, s69, 1792
    s_add_u32 s78, s78, 4096
    buffer_load_dwordx4 v22, s[48:51], s78 offen offset:0  lds
    v_mfma_f32_16x16x32_bf16 v[44:47], v[252:255], v[116:119], v[44:47]
    v_mfma_f32_16x16x32_bf16 v[48:51], v[248:251], v[120:123], v[48:51]
    v_mfma_f32_16x16x32_bf16 v[52:55], v[252:255], v[120:123], v[52:55]
    s_add_u32 s69, s69, 128
    s_and_b32 s69, s69, 0x3ff
    s_mul_i32 s78, s69, 1792
    s_add_u32 s78, s78, 3072
    buffer_load_dwordx4 v22, s[48:51], s78 offen offset:1024  lds
    v_mfma_f32_16x16x32_bf16 v[56:59], v[248:251], v[124:127], v[56:59]
    v_mfma_f32_16x16x32_bf16 v[60:63], v[252:255], v[124:127], v[60:63]
    ds_read_b64_tr_b16 v[104:105], v12 offset:16384
    ds_read_b64_tr_b16 v[106:107], v12 offset:16896
    ds_read_b64_tr_b16 v[108:109], v13 offset:16384
    ds_read_b64_tr_b16 v[110:111], v13 offset:16896
    v_fma_f32 v88, v32, s22, v26
    v_fma_f32 v89, v33, s22, v26
    v_fma_f32 v90, v34, s22, v26
    v_fma_f32 v91, v35, s22, v26
    v_exp_f32_e64 v88, v88 clamp
    v_exp_f32_e64 v89, v89 clamp
    v_exp_f32_e64 v90, v90 clamp
    v_exp_f32_e64 v91, v91 clamp
    v_max_f32 v32, s23, v32
    v_max_f32 v33, s23, v33
    v_max_f32 v34, s23, v34
    v_max_f32 v35, s23, v35
    v_add_f32 v32, v32, v88
    v_add_f32 v33, v33, v89
    v_add_f32 v34, v34, v90
    v_add_f32 v35, v35, v91
    v_cvt_pk_bf16_f32 v32, v32, v33
    v_cvt_pk_bf16_f32 v33, v34, v35
    v_fma_f32 v88, v36, s22, v26
    v_fma_f32 v89, v37, s22, v26
    v_fma_f32 v90, v38, s22, v26
    v_fma_f32 v91, v39, s22, v26
    v_exp_f32_e64 v88, v88 clamp
    v_exp_f32_e64 v89, v89 clamp
    v_exp_f32_e64 v90, v90 clamp
    v_exp_f32_e64 v91, v91 clamp
    v_max_f32 v36, s23, v36
    v_max_f32 v37, s23, v37
    v_max_f32 v38, s23, v38
    v_max_f32 v39, s23, v39
    v_add_f32 v36, v36, v88
    v_add_f32 v37, v37, v89
    v_add_f32 v38, v38, v90
    v_add_f32 v39, v39, v91
    v_cvt_pk_bf16_f32 v34, v36, v37
    v_cvt_pk_bf16_f32 v35, v38, v39
    v_cvt_pk_bf16_f32 v48, v48, v49
    v_cvt_pk_bf16_f32 v49, v50, v51
    v_cvt_pk_bf16_f32 v50, v52, v53
    v_cvt_pk_bf16_f32 v51, v54, v55
    s_nop 1
    v_mfma_f32_16x16x32_bf16 v[52:55], v[32:35], v[48:51], 0
    v_mfma_f32_16x16x32_bf16 v[36:39], v[92:95], v[32:35], 0
    v_fma_f32 v88, v40, s22, v26
    v_fma_f32 v89, v41, s22, v26
    v_fma_f32 v90, v42, s22, v26
    v_fma_f32 v91, v43, s22, v26
    v_exp_f32_e64 v88, v88 clamp
    v_exp_f32_e64 v89, v89 clamp
    v_exp_f32_e64 v90, v90 clamp
    v_exp_f32_e64 v91, v91 clamp
    v_max_f32 v40, s23, v40
    v_max_f32 v41, s23, v41
    v_max_f32 v42, s23, v42
    v_max_f32 v43, s23, v43
    v_add_f32 v40, v40, v88
    v_add_f32 v41, v41, v89
    v_add_f32 v42, v42, v90
    v_add_f32 v43, v43, v91
    v_cvt_pk_bf16_f32 v40, v40, v41
    v_cvt_pk_bf16_f32 v41, v42, v43
    v_fma_f32 v88, v44, s22, v26
    v_fma_f32 v89, v45, s22, v26
    v_fma_f32 v90, v46, s22, v26
    v_fma_f32 v91, v47, s22, v26
    v_exp_f32_e64 v88, v88 clamp
    v_exp_f32_e64 v89, v89 clamp
    v_exp_f32_e64 v90, v90 clamp
    v_exp_f32_e64 v91, v91 clamp
    v_max_f32 v44, s23, v44
    v_max_f32 v45, s23, v45
    v_max_f32 v46, s23, v46
    v_max_f32 v47, s23, v47
    v_add_f32 v44, v44, v88
    v_add_f32 v45, v45, v89
    v_add_f32 v46, v46, v90
    v_add_f32 v47, v47, v91
    v_cvt_pk_bf16_f32 v42, v44, v45
    v_cvt_pk_bf16_f32 v43, v46, v47
    v_cvt_pk_bf16_f32 v56, v56, v57
    v_cvt_pk_bf16_f32 v57, v58, v59
    v_cvt_pk_bf16_f32 v58, v60, v61
    v_cvt_pk_bf16_f32 v59, v62, v63
    s_nop 1
    v_mfma_f32_16x16x32_bf16 v[60:63], v[40:43], v[56:59], 0
    v_mfma_f32_16x16x32_bf16 v[44:47], v[92:95], v[40:43], 0
    ds_write_b128 v24, v[52:55] offset:0
    ds_write_b32 v25, v36 offset:0
    s_nop 4
    ds_write_b128 v24, v[60:63] offset:1024
    ds_write_b32 v25, v44 offset:64
    s_waitcnt lgkmcnt(0)
    s_barrier
    ds_read_b128 v[32:35], v16 offset:0
    ds_read_b128 v[36:39], v16 offset:4096
    ds_read_b128 v[40:43], v16 offset:8192
    ds_read_b128 v[44:47], v16 offset:12288
    ds_read_b32 v48, v29 offset:0
    ds_read_b32 v49, v29 offset:256
    ds_read_b32 v50, v29 offset:512
    ds_read_b32 v51, v29 offset:768
    ds_read_b64_tr_b16 v[112:113], v12 offset:1024
    ds_read_b64_tr_b16 v[114:115], v12 offset:1536
    v_mfma_f32_16x16x32_bf16 v[64:67], v[96:99], v[128:131], v[64:67]
    ds_read_b64_tr_b16 v[116:117], v13 offset:1024
    ds_read_b64_tr_b16 v[118:119], v13 offset:1536
    s_waitcnt lgkmcnt(10)
    v_add_f32 v32, v32, v36
    v_add_f32 v33, v33, v37
    v_add_f32 v34, v34, v38
    v_add_f32 v35, v35, v39
    s_waitcnt lgkmcnt(8)
    v_add_f32 v40, v40, v44
    v_add_f32 v41, v41, v45
    s_add_u32 s69, s69, 128
    s_and_b32 s69, s69, 0x3ff
    s_mul_i32 s78, s69, 1792
    s_add_u32 s78, s78, 2048
    buffer_load_dwordx4 v22, s[48:51], s78 offen offset:2048  lds
    v_mfma_f32_16x16x32_bf16 v[68:71], v[96:99], v[132:135], v[68:71]
    v_add_f32 v42, v42, v46
    v_add_f32 v43, v43, v47
    v_add_f32 v32, v32, v40
    v_add_f32 v33, v33, v41
    v_add_f32 v34, v34, v42
    v_add_f32 v35, v35, v43
    v_mfma_f32_16x16x32_bf16 v[72:75], v[100:103], v[128:131], v[72:75]
    s_waitcnt lgkmcnt(6)
    v_add_f32 v48, v48, v49
    s_waitcnt lgkmcnt(4)
    v_add_f32 v50, v50, v51
    v_add_f32 v48, v48, v50
    s_cmp_lt_u32 s3, 4
    s_cselect_b64 exec, -1, 0
    buffer_store_dwordx4 v[32:35], v2, s[60:63], s79 offen offset:0 sc1
    s_mov_b32 exec_hi, 0
    buffer_store_dword v48, v27, s[60:63], s15 offen sc1
    s_mov_b64 exec, -1
    v_lshrrev_b32 v29, 2, v1
    s_mul_i32 s13, s10, 8224
    s_add_u32 s69, s69, 128
    s_and_b32 s69, s69, 0x3ff
    s_mul_i32 s78, s69, 1792
    s_add_u32 s78, s78, 1024
    buffer_load_dwordx4 v22, s[48:51], s78 offen offset:3072  lds
    v_mfma_f32_16x16x32_bf16 v[76:79], v[100:103], v[132:135], v[76:79]
    v_lshl_add_u32 v29, v29, 7, v31
    s_lshl2_add_u32 s14, s11, s10
    v_xor_b32 v4, s13, v29
    s_lshl_b32 s14, s14, 11
    v_xor_b32 v5, 32, v4
    v_xor_b32 v6, 64, v4
    ds_read_b64_tr_b16 v[120:121], v12 offset:17408
    ds_read_b64_tr_b16 v[122:123], v12 offset:17920
    v_mfma_f32_16x16x32_bf16 v[64:67], v[104:107], v[136:139], v[64:67]
    ds_read_b64_tr_b16 v[124:125], v13 offset:17408
    ds_read_b64_tr_b16 v[126:127], v13 offset:17920
    v_xor_b32 v7, 96, v4
    s_add_u32 s14, s14, 0
    v_add_u32 v8, 0x10000, v4
    v_add_u32 v9, 0x10000, v5
    v_add_u32 v10, 0x10000, v6
    v_add_u32 v11, 0x10000, v7
    v_mfma_f32_16x16x32_bf16 v[68:71], v[104:107], v[140:143], v[68:71]
    v_add_u32 v20, s14, v2
    v_xor_b32 v17, 2048, v20
    v_xor_b32 v18, 4096, v20
    v_xor_b32 v19, 6144, v20
    v_add_u32 v29, 0x1000, v2
    v_add_u32 v31, 0x2000, v2
    v_mfma_f32_16x16x32_bf16 v[72:75], v[108:111], v[136:139], v[72:75]
    v_mfma_f32_16x16x32_bf16 v[76:79], v[108:111], v[140:143], v[76:79]
    s_waitcnt lgkmcnt(4)
    ds_read_b64_tr_b16 v[96:97], v12 offset:2048
    ds_read_b64_tr_b16 v[98:99], v12 offset:2560
    v_mfma_f32_16x16x32_bf16 v[64:67], v[112:115], v[144:147], v[64:67]
    ds_read_b64_tr_b16 v[100:101], v13 offset:2048
    ds_read_b64_tr_b16 v[102:103], v13 offset:2560
    v_mfma_f32_16x16x32_bf16 v[68:71], v[112:115], v[148:151], v[68:71]
    v_mfma_f32_16x16x32_bf16 v[72:75], v[116:119], v[144:147], v[72:75]
    v_mfma_f32_16x16x32_bf16 v[76:79], v[116:119], v[148:151], v[76:79]
    s_waitcnt lgkmcnt(4)
    ds_read_b64_tr_b16 v[104:105], v12 offset:18432
    ds_read_b64_tr_b16 v[106:107], v12 offset:18944
    v_mfma_f32_16x16x32_bf16 v[64:67], v[120:123], v[152:155], v[64:67]
    ds_read_b64_tr_b16 v[108:109], v13 offset:18432
    ds_read_b64_tr_b16 v[110:111], v13 offset:18944
    v_mfma_f32_16x16x32_bf16 v[68:71], v[120:123], v[156:159], v[68:71]
    v_mfma_f32_16x16x32_bf16 v[72:75], v[124:127], v[152:155], v[72:75]
    v_mfma_f32_16x16x32_bf16 v[76:79], v[124:127], v[156:159], v[76:79]
    s_waitcnt lgkmcnt(4)
    ds_read_b64_tr_b16 v[112:113], v12 offset:3072
    ds_read_b64_tr_b16 v[114:115], v12 offset:3584
    v_mfma_f32_16x16x32_bf16 v[64:67], v[96:99], v[160:163], v[64:67]
    ds_read_b64_tr_b16 v[116:117], v13 offset:3072
    ds_read_b64_tr_b16 v[118:119], v13 offset:3584
    v_mfma_f32_16x16x32_bf16 v[68:71], v[96:99], v[164:167], v[68:71]
    v_mfma_f32_16x16x32_bf16 v[72:75], v[100:103], v[160:163], v[72:75]
    v_mfma_f32_16x16x32_bf16 v[76:79], v[100:103], v[164:167], v[76:79]
    s_waitcnt lgkmcnt(4)
    s_waitcnt vmcnt(1)
    s_cmp_lt_u32 s3, 4
    s_cselect_b64 exec, 1, 0
    buffer_store_dword v0, v27, s[60:63], s34 offen sc1
    s_mov_b64 exec, -1
    ds_read_b64_tr_b16 v[120:121], v12 offset:19456
    ds_read_b64_tr_b16 v[122:123], v12 offset:19968
    v_mfma_f32_16x16x32_bf16 v[64:67], v[104:107], v[168:171], v[64:67]
    ds_read_b64_tr_b16 v[124:125], v13 offset:19456
    ds_read_b64_tr_b16 v[126:127], v13 offset:19968
    v_mfma_f32_16x16x32_bf16 v[68:71], v[104:107], v[172:175], v[68:71]
    v_mfma_f32_16x16x32_bf16 v[72:75], v[108:111], v[168:171], v[72:75]
    v_mfma_f32_16x16x32_bf16 v[76:79], v[108:111], v[172:175], v[76:79]
    s_waitcnt lgkmcnt(0)
    s_barrier
    ds_read_b64_tr_b16 v[96:97], v12 offset:32768
    ds_read_b64_tr_b16 v[98:99], v12 offset:33280
    v_mfma_f32_16x16x32_bf16 v[64:67], v[112:115], v[176:179], v[64:67]
    ds_read_b64_tr_b16 v[100:101], v13 offset:32768
    ds_read_b64_tr_b16 v[102:103], v13 offset:33280
    s_add_u32 m0, s68, 98304
    s_add_u32 s69, s69, 128
    s_and_b32 s69, s69, 0x3ff
    s_mul_i32 s78, s69, 1792
    s_add_u32 s78, s78, 4096
    buffer_load_dwordx4 v22, s[48:51], s78 offen offset:0  lds
    v_mfma_f32_16x16x32_bf16 v[68:71], v[112:115], v[180:183], v[68:71]
    v_mfma_f32_16x16x32_bf16 v[72:75], v[116:119], v[176:179], v[72:75]
    s_add_u32 s69, s69, 128
    s_and_b32 s69, s69, 0x3ff
    s_mul_i32 s78, s69, 1792
    s_add_u32 s78, s78, 3072
    buffer_load_dwordx4 v22, s[48:51], s78 offen offset:1024  lds
    v_mfma_f32_16x16x32_bf16 v[76:79], v[116:119], v[180:183], v[76:79]
    ds_read_b64_tr_b16 v[104:105], v12 offset:49152
    ds_read_b64_tr_b16 v[106:107], v12 offset:49664
    v_mfma_f32_16x16x32_bf16 v[64:67], v[120:123], v[184:187], v[64:67]
    ds_read_b64_tr_b16 v[108:109], v13 offset:49152
    ds_read_b64_tr_b16 v[110:111], v13 offset:49664
    s_add_u32 s69, s69, 128
    s_and_b32 s69, s69, 0x3ff
    s_mul_i32 s78, s69, 1792
    s_add_u32 s78, s78, 2048
    buffer_load_dwordx4 v22, s[48:51], s78 offen offset:2048  lds
    v_mfma_f32_16x16x32_bf16 v[68:71], v[120:123], v[188:191], v[68:71]
    v_mfma_f32_16x16x32_bf16 v[72:75], v[124:127], v[184:187], v[72:75]
    s_add_u32 s69, s69, 128
    s_and_b32 s69, s69, 0x3ff
    s_mul_i32 s78, s69, 1792
    s_add_u32 s78, s78, 1024
    buffer_load_dwordx4 v22, s[48:51], s78 offen offset:3072  lds
    v_mfma_f32_16x16x32_bf16 v[76:79], v[124:127], v[188:191], v[76:79]
    s_waitcnt lgkmcnt(4)
    ds_read_b64_tr_b16 v[112:113], v12 offset:33792
    ds_read_b64_tr_b16 v[114:115], v12 offset:34304
    v_mfma_f32_16x16x32_bf16 v[64:67], v[96:99], v[192:195], v[64:67]
    ds_read_b64_tr_b16 v[116:117], v13 offset:33792
    ds_read_b64_tr_b16 v[118:119], v13 offset:34304
    buffer_load_dword v28, v27, s[60:63], s84 offen sc1
    v_mfma_f32_16x16x32_bf16 v[68:71], v[96:99], v[196:199], v[68:71]
    v_mfma_f32_16x16x32_bf16 v[72:75], v[100:103], v[192:195], v[72:75]
    s_add_u32 m0, s68, 0
    s_add_u32 s78, s74, 200704
    buffer_load_dwordx4 v23, s[52:55], s78 offen offset:0  lds
    v_mfma_f32_16x16x32_bf16 v[76:79], v[100:103], v[196:199], v[76:79]
    s_waitcnt lgkmcnt(4)
    ds_read_b64_tr_b16 v[120:121], v12 offset:50176
    ds_read_b64_tr_b16 v[122:123], v12 offset:50688
    v_mfma_f32_16x16x32_bf16 v[64:67], v[104:107], v[200:203], v[64:67]
    ds_read_b64_tr_b16 v[124:125], v13 offset:50176
    ds_read_b64_tr_b16 v[126:127], v13 offset:50688
    s_add_u32 s78, s74, 207872
    buffer_load_dwordx4 v23, s[52:55], s78 offen offset:1024  lds
    v_mfma_f32_16x16x32_bf16 v[68:71], v[104:107], v[204:207], v[68:71]
    v_mfma_f32_16x16x32_bf16 v[72:75], v[108:111], v[200:203], v[72:75]
    s_add_u32 s78, s74, 231424
    buffer_load_dwordx4 v23, s[52:55], s78 offen offset:2048  lds
    v_mfma_f32_16x16x32_bf16 v[76:79], v[108:111], v[204:207], v[76:79]
    s_waitcnt lgkmcnt(4)
    s_waitcnt vmcnt(3)
    v_cmp_ne_u32 vcc, s12, v28
    s_nop 0
    s_and_b64 vcc, vcc, s[16:17]
    s_cbranch_scc0 L_ok4
    s_mov_b32 s86, 0
L_sp5:
    s_sleep 1
    buffer_load_dword v28, v27, s[60:63], s84 offen sc1
    s_waitcnt vmcnt(0)
    v_cmp_ne_u32 vcc, s12, v28
    s_nop 0
    s_and_b64 vcc, vcc, s[16:17]
    s_cbranch_scc0 L_ok4
    s_add_u32 s86, s86, 1
    s_and_b32 vcc_lo, s86, 7
    s_cbranch_scc1 L_sp5
    buffer_load_dword v28, v27, s[60:63], s24 offen sc1
    s_waitcnt vmcnt(0)
    v_cmp_ne_u32 vcc, s12, v28
    v_mov_b32 v28, 0
    s_and_b32 vcc_lo, vcc_lo, 0xf
    s_cbranch_scc0 L_ok4
    s_cmp_lt_u32 s86, 0x100000
    s_cbranch_scc1 L_sp5
L_ok4:
    ds_read_b64_tr_b16 v[96:97], v12 offset:34816
    ds_read_b64_tr_b16 v[98:99], v12 offset:35328
    v_mfma_f32_16x16x32_bf16 v[64:67], v[112:115], v[208:211], v[64:67]
    ds_read_b64_tr_b16 v[100:101], v13 offset:34816
    ds_read_b64_tr_b16 v[102:103], v13 offset:35328
    s_add_u32 s78, s74, 238592
    buffer_load_dwordx4 v23, s[52:55], s78 offen offset:3072  lds
    v_mfma_f32_16x16x32_bf16 v[68:71], v[112:115], v[212:215], v[68:71]
    v_mfma_f32_16x16x32_bf16 v[72:75], v[116:119], v[208:211], v[72:75]
    buffer_load_dwordx4 v[132:135], v2, s[60:63], s80 offen offset:0 sc1
    v_mfma_f32_16x16x32_bf16 v[76:79], v[116:119], v[212:215], v[76:79]
    s_waitcnt lgkmcnt(4)
    ds_read_b64_tr_b16 v[104:105], v12 offset:51200
    ds_read_b64_tr_b16 v[106:107], v12 offset:51712
    v_mfma_f32_16x16x32_bf16 v[64:67], v[120:123], v[216:219], v[64:67]
    ds_read_b64_tr_b16 v[108:109], v13 offset:51200
    ds_read_b64_tr_b16 v[110:111], v13 offset:51712
    buffer_load_dwordx4 v[140:143], v2, s[60:63], s81 offen offset:0 sc1
    v_mfma_f32_16x16x32_bf16 v[68:71], v[120:123], v[220:223], v[68:71]
    v_mfma_f32_16x16x32_bf16 v[72:75], v[124:127], v[216:219], v[72:75]
    buffer_load_dwordx4 v[148:151], v2, s[60:63], s80 offen offset:1024 sc1
    v_mfma_f32_16x16x32_bf16 v[76:79], v[124:127], v[220:223], v[76:79]
    s_waitcnt lgkmcnt(4)
    ds_read_b64_tr_b16 v[112:113], v12 offset:35840
    ds_read_b64_tr_b16 v[114:115], v12 offset:36352
    v_mfma_f32_16x16x32_bf16 v[64:67], v[96:99], v[224:227], v[64:67]
    ds_read_b64_tr_b16 v[116:117], v13 offset:35840
    ds_read_b64_tr_b16 v[118:119], v13 offset:36352
    buffer_load_dwordx4 v[156:159], v2, s[60:63], s81 offen offset:1024 sc1
    v_mfma_f32_16x16x32_bf16 v[68:71], v[96:99], v[228:231], v[68:71]
    v_mfma_f32_16x16x32_bf16 v[72:75], v[100:103], v[224:227], v[72:75]
    buffer_load_dwordx4 v[164:167], v2, s[60:63], s80 offen offset:2048 sc1
    v_mfma_f32_16x16x32_bf16 v[76:79], v[100:103], v[228:231], v[76:79]
    s_waitcnt lgkmcnt(4)
    ds_read_b64_tr_b16 v[120:121], v12 offset:52224
    ds_read_b64_tr_b16 v[122:123], v12 offset:52736
    v_mfma_f32_16x16x32_bf16 v[64:67], v[104:107], v[232:235], v[64:67]
    ds_read_b64_tr_b16 v[124:125], v13 offset:52224
    ds_read_b64_tr_b16 v[126:127], v13 offset:52736
    buffer_load_dwordx4 v[172:175], v2, s[60:63], s81 offen offset:2048 sc1
    v_mfma_f32_16x16x32_bf16 v[68:71], v[104:107], v[236:239], v[68:71]
    v_mfma_f32_16x16x32_bf16 v[72:75], v[108:111], v[232:235], v[72:75]
    buffer_load_dwordx4 v[180:183], v2, s[60:63], s80 offen offset:3072 sc1
    v_mfma_f32_16x16x32_bf16 v[76:79], v[108:111], v[236:239], v[76:79]
    s_waitcnt lgkmcnt(0)
    s_barrier
    ds_read_b64_tr_b16 v[96:97], v14 offset:0
    ds_read_b64_tr_b16 v[98:99], v14 offset:512
    v_mfma_f32_16x16x32_bf16 v[64:67], v[112:115], v[240:243], v[64:67]
    ds_read_b64_tr_b16 v[100:101], v15 offset:0
    ds_read_b64_tr_b16 v[102:103], v15 offset:512
    buffer_load_dwordx4 v[188:191], v2, s[60:63], s81 offen offset:3072 sc1
    v_mfma_f32_16x16x32_bf16 v[68:71], v[112:115], v[244:247], v[68:71]
    v_mfma_f32_16x16x32_bf16 v[72:75], v[116:119], v[240:243], v[72:75]
    buffer_load_dwordx4 v[196:199], v2, s[60:63], s82 offen offset:0 sc1
    v_mfma_f32_16x16x32_bf16 v[76:79], v[116:119], v[244:247], v[76:79]
    ds_read_b64_tr_b16 v[104:105], v14 offset:16384
    ds_read_b64_tr_b16 v[106:107], v14 offset:16896
    v_mfma_f32_16x16x32_bf16 v[64:67], v[120:123], v[248:251], v[64:67]
    ds_read_b64_tr_b16 v[108:109], v15 offset:16384
    ds_read_b64_tr_b16 v[110:111], v15 offset:16896
    buffer_load_dwordx4 v[204:207], v2, s[60:63], s83 offen offset:0 sc1
    v_mfma_f32_16x16x32_bf16 v[68:71], v[120:123], v[252:255], v[68:71]
    v_mfma_f32_16x16x32_bf16 v[72:75], v[124:127], v[248:251], v[72:75]
    buffer_load_dwordx4 v[212:215], v2, s[60:63], s82 offen offset:1024 sc1
    v_mfma_f32_16x16x32_bf16 v[76:79], v[124:127], v[252:255], v[76:79]
    s_waitcnt lgkmcnt(4)
    ds_read_b64_tr_b16 v[112:113], v14 offset:1024
    ds_read_b64_tr_b16 v[114:115], v14 offset:1536
    ds_read_b64_tr_b16 v[116:117], v15 offset:1024
    ds_read_b64_tr_b16 v[118:119], v15 offset:1536
    v_mfma_f32_16x16x32_bf16 v[80:83], v[96:99], v[128:131], v[80:83]
    v_add_u32 v13, 0x10000, v8
    ds_read_b64_tr_b16 v[228:229], v13 offset:0
    ds_read_b64_tr_b16 v[230:231], v13 offset:4096
    v_add_u32 v13, 0x10000, v9
    ds_read_b64_tr_b16 v[236:237], v13 offset:0
    ds_read_b64_tr_b16 v[238:239], v13 offset:4096
    s_add_u32 s72, s72, 4096
    s_add_u32 s73, s73, 4096
    v_max_f32 v64, 0, v64
    v_max_f32 v65, 0, v65
    buffer_load_dwordx4 v[220:223], v2, s[60:63], s83 offen offset:1024 sc1
    v_mfma_f32_16x16x32_bf16 v[84:87], v[100:103], v[128:131], v[84:87]
    v_add_u32 v13, 0x10000, v10
    ds_read_b64_tr_b16 v[244:245], v13 offset:0
    ds_read_b64_tr_b16 v[246:247], v13 offset:4096
    v_add_u32 v13, 0x10000, v11
    ds_read_b64_tr_b16 v[252:253], v13 offset:0
    ds_read_b64_tr_b16 v[254:255], v13 offset:4096
    v_max_f32 v66, 0, v66
    v_max_f32 v67, 0, v67
    v_mul_f32 v64, v64, v64
    v_mul_f32 v65, v65, v65
    s_waitcnt lgkmcnt(12)
    ds_read_b64_tr_b16 v[120:121], v14 offset:17408
    ds_read_b64_tr_b16 v[122:123], v14 offset:17920
    ds_read_b64_tr_b16 v[124:125], v15 offset:17408
    ds_read_b64_tr_b16 v[126:127], v15 offset:17920
    v_mfma_f32_16x16x32_bf16 v[80:83], v[104:107], v[136:139], v[80:83]
    v_mul_f32 v66, v66, v66
    v_mul_f32 v67, v67, v67
    v_cvt_pk_bf16_f32 v88, v64, v65
    v_cvt_pk_bf16_f32 v89, v66, v67
    s_add_u32 m0, s68, 32768
    s_add_u32 s78, s75, 4096
    buffer_load_dwordx4 v23, s[52:55], s78 offen offset:0  lds
    v_mfma_f32_16x16x32_bf16 v[84:87], v[108:111], v[136:139], v[84:87]
    v_max_f32 v72, 0, v72
    v_max_f32 v73, 0, v73
    v_max_f32 v74, 0, v74
    v_max_f32 v75, 0, v75
    s_waitcnt lgkmcnt(12)
    ds_read_b64_tr_b16 v[96:97], v14 offset:2048
    ds_read_b64_tr_b16 v[98:99], v14 offset:2560
    ds_read_b64_tr_b16 v[100:101], v15 offset:2048
    ds_read_b64_tr_b16 v[102:103], v15 offset:2560
    v_mfma_f32_16x16x32_bf16 v[80:83], v[112:115], v[144:147], v[80:83]
    v_mul_f32 v72, v72, v72
    v_mul_f32 v73, v73, v73
    v_mul_f32 v74, v74, v74
    v_mul_f32 v75, v75, v75
    s_add_u32 s78, s75, 11264
    buffer_load_dwordx4 v23, s[52:55], s78 offen offset:1024  lds
    v_mfma_f32_16x16x32_bf16 v[84:87], v[116:119], v[144:147], v[84:87]
    v_cvt_pk_bf16_f32 v90, v72, v73
    v_cvt_pk_bf16_f32 v91, v74, v75
    buffer_store_dwordx4 v[88:91], v2, s[60:63], s72 offen offset:0 sc1
    v_max_f32 v68, 0, v68
    s_waitcnt lgkmcnt(4)
    ds_read_b64_tr_b16 v[104:105], v14 offset:18432
    ds_read_b64_tr_b16 v[106:107], v14 offset:18944
    ds_read_b64_tr_b16 v[108:109], v15 offset:18432
    ds_read_b64_tr_b16 v[110:111], v15 offset:18944
    v_mfma_f32_16x16x32_bf16 v[80:83], v[120:123], v[152:155], v[80:83]
    v_max_f32 v69, 0, v69
    v_max_f32 v70, 0, v70
    v_max_f32 v71, 0, v71
    v_mul_f32 v68, v68, v68
    s_add_u32 s78, s75, 34816
    buffer_load_dwordx4 v23, s[52:55], s78 offen offset:2048  lds
    v_mfma_f32_16x16x32_bf16 v[84:87], v[124:127], v[152:155], v[84:87]
    v_mul_f32 v69, v69, v69
    v_mul_f32 v70, v70, v70
    v_mul_f32 v71, v71, v71
    v_cvt_pk_bf16_f32 v92, v68, v69
    s_waitcnt lgkmcnt(4)
    ds_read_b64_tr_b16 v[112:113], v14 offset:3072
    ds_read_b64_tr_b16 v[114:115], v14 offset:3584
    ds_read_b64_tr_b16 v[116:117], v15 offset:3072
    ds_read_b64_tr_b16 v[118:119], v15 offset:3584
    v_mfma_f32_16x16x32_bf16 v[80:83], v[96:99], v[160:163], v[80:83]
    v_add_u32 v13, 0x10000, v8
    ds_read_b64_tr_b16 v[128:129], v13 offset:2048
    ds_read_b64_tr_b16 v[130:131], v13 offset:6144
    v_add_u32 v13, 0x10000, v9
    ds_read_b64_tr_b16 v[136:137], v13 offset:2048
    ds_read_b64_tr_b16 v[138:139], v13 offset:6144
    v_cvt_pk_bf16_f32 v93, v70, v71
    v_max_f32 v76, 0, v76
    v_max_f32 v77, 0, v77
    v_max_f32 v78, 0, v78
    s_add_u32 s78, s75, 41984
    buffer_load_dwordx4 v23, s[52:55], s78 offen offset:3072  lds
    v_mfma_f32_16x16x32_bf16 v[84:87], v[100:103], v[160:163], v[84:87]
    v_add_u32 v13, 0x10000, v10
    ds_read_b64_tr_b16 v[144:145], v13 offset:2048
    ds_read_b64_tr_b16 v[146:147], v13 offset:6144
    v_add_u32 v13, 0x10000, v11
    ds_read_b64_tr_b16 v[152:153], v13 offset:2048
    ds_read_b64_tr_b16 v[154:155], v13 offset:6144
    v_max_f32 v79, 0, v79
    v_mul_f32 v76, v76, v76
    v_mul_f32 v77, v77, v77
    v_mul_f32 v78, v78, v78
    s_waitcnt lgkmcnt(12)
    ds_read_b64_tr_b16 v[120:121], v14 offset:19456
    ds_read_b64_tr_b16 v[122:123], v14 offset:19968
    ds_read_b64_tr_b16 v[124:125], v15 offset:19456
    ds_read_b64_tr_b16 v[126:127], v15 offset:19968
    v_mfma_f32_16x16x32_bf16 v[80:83], v[104:107], v[168:171], v[80:83]
    v_mul_f32 v79, v79, v79
    v_cvt_pk_bf16_f32 v94, v76, v77
    v_cvt_pk_bf16_f32 v95, v78, v79
    buffer_store_dwordx4 v[92:95], v2, s[60:63], s73 offen offset:0 sc1
    v_mfma_f32_16x16x32_bf16 v[84:87], v[108:111], v[168:171], v[84:87]
    s_sub_u32 s13, s11, s8
    s_mul_i32 s13, s13, 9216
    s_lshl_b32 s14, s11, 10
    s_sub_u32 s13, s13, s14
    s_waitcnt vmcnt(18) lgkmcnt(0)
    s_barrier
    ds_read_b64_tr_b16 v[96:97], v14 offset:32768
    ds_read_b64_tr_b16 v[98:99], v14 offset:33280
    ds_read_b64_tr_b16 v[100:101], v15 offset:32768
    ds_read_b64_tr_b16 v[102:103], v15 offset:33280
    v_mfma_f32_16x16x32_bf16 v[80:83], v[112:115], v[176:179], v[80:83]
    s_add_u32 s72, s13, s72
    s_add_u32 m0, s68, 65536
    s_add_u32 s78, s76, 397312
    buffer_load_dwordx4 v23, s[52:55], s78 offen offset:0  lds
    v_mfma_f32_16x16x32_bf16 v[84:87], v[116:119], v[176:179], v[84:87]
    ds_read_b64_tr_b16 v[104:105], v14 offset:49152
    ds_read_b64_tr_b16 v[106:107], v14 offset:49664
    ds_read_b64_tr_b16 v[108:109], v15 offset:49152
    ds_read_b64_tr_b16 v[110:111], v15 offset:49664
    v_mfma_f32_16x16x32_bf16 v[80:83], v[120:123], v[184:187], v[80:83]
    s_add_u32 s78, s76, 404480
    buffer_load_dwordx4 v23, s[52:55], s78 offen offset:1024  lds
    v_mfma_f32_16x16x32_bf16 v[84:87], v[124:127], v[184:187], v[84:87]
    s_waitcnt lgkmcnt(4)
    ds_read_b64_tr_b16 v[112:113], v14 offset:33792
    ds_read_b64_tr_b16 v[114:115], v14 offset:34304
    ds_read_b64_tr_b16 v[116:117], v15 offset:33792
    ds_read_b64_tr_b16 v[118:119], v15 offset:34304
    v_mfma_f32_16x16x32_bf16 v[80:83], v[96:99], v[192:195], v[80:83]
    ds_read_b64_tr_b16 v[160:161], v4 offset:0
    ds_read_b64_tr_b16 v[162:163], v4 offset:4096
    s_add_u32 s78, s77, 2048
    buffer_load_dwordx4 v23, s[56:59], s78 offen offset:2048  lds
    v_mfma_f32_16x16x32_bf16 v[84:87], v[100:103], v[192:195], v[84:87]
    ds_read_b64_tr_b16 v[168:169], v5 offset:0
    ds_read_b64_tr_b16 v[170:171], v5 offset:4096
    s_waitcnt lgkmcnt(8)
    ds_read_b64_tr_b16 v[120:121], v14 offset:50176
    ds_read_b64_tr_b16 v[122:123], v14 offset:50688
    ds_read_b64_tr_b16 v[124:125], v15 offset:50176
    ds_read_b64_tr_b16 v[126:127], v15 offset:50688
    v_mfma_f32_16x16x32_bf16 v[80:83], v[104:107], v[200:203], v[80:83]
    ds_read_b64_tr_b16 v[176:177], v6 offset:0
    ds_read_b64_tr_b16 v[178:179], v6 offset:4096
    s_add_u32 s78, s77, 9216
    buffer_load_dwordx4 v23, s[56:59], s78 offen offset:3072  lds
    v_mfma_f32_16x16x32_bf16 v[84:87], v[108:111], v[200:203], v[84:87]
    ds_read_b64_tr_b16 v[184:185], v7 offset:0
    ds_read_b64_tr_b16 v[186:187], v7 offset:4096
    s_waitcnt lgkmcnt(12)
    ds_read_b64_tr_b16 v[96:97], v14 offset:34816
    ds_read_b64_tr_b16 v[98:99], v14 offset:35328
    ds_read_b64_tr_b16 v[100:101], v15 offset:34816
    ds_read_b64_tr_b16 v[102:103], v15 offset:35328
    v_mfma_f32_16x16x32_bf16 v[80:83], v[112:115], v[208:211], v[80:83]
    v_mfma_f32_16x16x32_bf16 v[84:87], v[116:119], v[208:211], v[84:87]
    s_waitcnt lgkmcnt(8)
    ds_read_b64_tr_b16 v[104:105], v14 offset:51200
    ds_read_b64_tr_b16 v[106:107], v14 offset:51712
    ds_read_b64_tr_b16 v[108:109], v15 offset:51200
    ds_read_b64_tr_b16 v[110:111], v15 offset:51712
    v_mfma_f32_16x16x32_bf16 v[80:83], v[120:123], v[216:219], v[80:83]
    v_mfma_f32_16x16x32_bf16 v[84:87], v[124:127], v[216:219], v[84:87]
    s_waitcnt lgkmcnt(4)
    s_waitcnt vmcnt(4)
    s_mov_b64 exec, 1
    buffer_store_dword v0, v27, s[60:63], s85 offen offset:32
    s_mov_b64 exec, -1
    ds_read_b64_tr_b16 v[112:113], v14 offset:35840
    ds_read_b64_tr_b16 v[114:115], v14 offset:36352
    ds_read_b64_tr_b16 v[116:117], v15 offset:35840
    ds_read_b64_tr_b16 v[118:119], v15 offset:36352
    v_mfma_f32_16x16x32_bf16 v[80:83], v[96:99], v[224:227], v[80:83]
    ds_read_b64_tr_b16 v[192:193], v4 offset:2048
    ds_read_b64_tr_b16 v[194:195], v4 offset:6144
    v_mfma_f32_16x16x32_bf16 v[84:87], v[100:103], v[224:227], v[84:87]
    ds_read_b64_tr_b16 v[200:201], v5 offset:2048
    ds_read_b64_tr_b16 v[202:203], v5 offset:6144
    s_waitcnt lgkmcnt(8)
    ds_read_b64_tr_b16 v[120:121], v14 offset:52224
    ds_read_b64_tr_b16 v[122:123], v14 offset:52736
    ds_read_b64_tr_b16 v[124:125], v15 offset:52224
    ds_read_b64_tr_b16 v[126:127], v15 offset:52736
    v_mfma_f32_16x16x32_bf16 v[80:83], v[104:107], v[232:235], v[80:83]
    ds_read_b64_tr_b16 v[208:209], v6 offset:2048
    ds_read_b64_tr_b16 v[210:211], v6 offset:6144
    v_mfma_f32_16x16x32_bf16 v[84:87], v[108:111], v[232:235], v[84:87]
    ds_read_b64_tr_b16 v[216:217], v7 offset:2048
    ds_read_b64_tr_b16 v[218:219], v7 offset:6144
    s_waitcnt lgkmcnt(12)
    v_mfma_f32_16x16x32_bf16 v[80:83], v[112:115], v[240:243], v[80:83]
    v_mfma_f32_16x16x32_bf16 v[84:87], v[116:119], v[240:243], v[84:87]
    s_waitcnt lgkmcnt(4)
    v_mfma_f32_16x16x32_bf16 v[80:83], v[120:123], v[248:251], v[80:83]
    v_mfma_f32_16x16x32_bf16 v[84:87], v[124:127], v[248:251], v[84:87]
    s_nop 6
    v_max_f32 v80, 0, v80
    v_max_f32 v81, 0, v81
    v_max_f32 v82, 0, v82
    v_max_f32 v83, 0, v83
    v_mul_f32 v80, v80, v80
    v_mul_f32 v81, v81, v81
    v_mul_f32 v82, v82, v82
    v_mul_f32 v83, v83, v83
    v_cvt_pk_bf16_f32 v80, v80, v81
    v_cvt_pk_bf16_f32 v81, v82, v83
    v_max_f32 v84, 0, v84
    v_max_f32 v85, 0, v85
    v_max_f32 v86, 0, v86
    v_max_f32 v87, 0, v87
    v_mul_f32 v84, v84, v84
    v_mul_f32 v85, v85, v85
    v_mul_f32 v86, v86, v86
    v_mul_f32 v87, v87, v87
    v_cvt_pk_bf16_f32 v82, v84, v85
    v_cvt_pk_bf16_f32 v83, v86, v87
    buffer_load_dword v28, v27, s[60:63], s84 offen sc1
    buffer_store_dwordx4 v[80:83], v2, s[60:63], s72 offen offset:2048 sc1
    s_waitcnt lgkmcnt(0)
    s_barrier
    s_lshl_b32 s86, 1, s7
    s_cmp_eq_u32 s3, 0
    s_cselect_b32 exec_lo, s86, 0
    s_mov_b32 exec_hi, 0
    buffer_store_dword v0, v27, s[60:63], s24 offen offset:16 sc1
    s_mov_b64 exec, -1
    v_mfma_f32_16x16x32_bf16 v[32:35], v[228:231], v[132:135], 0
    ds_read_b64_tr_b16 v[224:225], v4 offset:32768
    ds_read_b64_tr_b16 v[226:227], v4 offset:36864
    v_and_b32 v24, 15, v1
    s_lshl1_add_u32 s13, s4, s11
    s_add_u32 m0, s68, 98304
    s_add_u32 s78, s77, 36864
    buffer_load_dwordx4 v23, s[56:59], s78 offen offset:0  lds
    v_mfma_f32_16x16x32_bf16 v[40:43], v[236:239], v[132:135], 0
    ds_read_b64_tr_b16 v[232:233], v5 offset:32768
    ds_read_b64_tr_b16 v[234:235], v5 offset:36864
    s_lshl2_add_u32 s13, s5, s13
    s_lshl_b32 s13, s13, 5
    v_mfma_f32_16x16x32_bf16 v[48:51], v[244:247], v[132:135], 0
    ds_read_b64_tr_b16 v[240:241], v6 offset:32768
    ds_read_b64_tr_b16 v[242:243], v6 offset:36864
    s_lshl_b32 s14, s4, 9
    v_lshl_add_u32 v16, v24, 2, s14
    s_add_u32 s78, s77, 44032
    buffer_load_dwordx4 v23, s[56:59], s78 offen offset:1024  lds
    v_mfma_f32_16x16x32_bf16 v[56:59], v[252:255], v[132:135], 0
    ds_read_b64_tr_b16 v[248:249], v7 offset:32768
    ds_read_b64_tr_b16 v[250:251], v7 offset:36864
    v_xor_b32 v21, 0x200, v16
    v_add_u32 v24, s13, v24
    v_mfma_f32_16x16x32_bf16 v[36:39], v[228:231], v[140:143], 0
    ds_read_b64_tr_b16 v[96:97], v4 offset:34816
    ds_read_b64_tr_b16 v[98:99], v4 offset:38912
    s_lshl2_add_u32 s13, s6, s10
    s_lshl_b32 s13, s13, 5
    v_mfma_f32_16x16x32_bf16 v[44:47], v[236:239], v[140:143], 0
    ds_read_b64_tr_b16 v[100:101], v5 offset:34816
    ds_read_b64_tr_b16 v[102:103], v5 offset:38912
    v_lshl_add_u32 v30, v3, 3, s13
    global_load_dwordx2 v[14:15], v30, s[30:31]
    v_mfma_f32_16x16x32_bf16 v[52:55], v[244:247], v[140:143], 0
    ds_read_b64_tr_b16 v[104:105], v6 offset:34816
    ds_read_b64_tr_b16 v[106:107], v6 offset:38912
    v_lshl_add_u32 v12, v24, 10, v30
    v_mfma_f32_16x16x32_bf16 v[60:63], v[252:255], v[140:143], 0
    ds_read_b64_tr_b16 v[108:109], v7 offset:34816
    ds_read_b64_tr_b16 v[110:111], v7 offset:38912
    v_mfma_f32_16x16x32_bf16 v[32:35], v[128:131], v[148:151], v[32:35]
    v_mfma_f32_16x16x32_bf16 v[40:43], v[136:139], v[148:151], v[40:43]
    v_mfma_f32_16x16x32_bf16 v[48:51], v[144:147], v[148:151], v[48:51]
    v_mfma_f32_16x16x32_bf16 v[56:59], v[152:155], v[148:151], v[56:59]
    v_mfma_f32_16x16x32_bf16 v[36:39], v[128:131], v[156:159], v[36:39]
    v_mfma_f32_16x16x32_bf16 v[44:47], v[136:139], v[156:159], v[44:47]
    v_mfma_f32_16x16x32_bf16 v[52:55], v[144:147], v[156:159], v[52:55]
    v_mfma_f32_16x16x32_bf16 v[60:63], v[152:155], v[156:159], v[60:63]
    s_waitcnt vmcnt(5)
    v_cmp_ne_u32 vcc, s12, v28
    s_nop 0
    s_and_b64 vcc, vcc, s[18:19]
    s_cbranch_scc0 L_ok6
    s_mov_b32 s86, 0
L_sp7:
    s_sleep 1
    buffer_load_dword v28, v27, s[60:63], s84 offen sc1
    s_waitcnt vmcnt(0)
    v_cmp_ne_u32 vcc, s12, v28
    s_nop 0
    s_and_b64 vcc, vcc, s[18:19]
    s_cbranch_scc0 L_ok6
    s_add_u32 s86, s86, 1
    s_and_b32 vcc_lo, s86, 7
    s_cbranch_scc1 L_sp7
    buffer_load_dword v28, v27, s[60:63], s24 offen sc1
    s_waitcnt vmcnt(0)
    v_cmp_ne_u32 vcc, s12, v28
    v_mov_b32 v28, 0
    s_and_b32 vcc_lo, vcc_lo, 0xf0
    s_cbranch_scc0 L_ok6
    s_cmp_lt_u32 s86, 0x100000
    s_cbranch_scc1 L_sp7
L_ok6:
    v_mfma_f32_16x16x32_bf16 v[32:35], v[160:163], v[164:167], v[32:35]
    buffer_load_dwordx4 v[132:135], v29, s[60:63], s80 offen offset:0 sc1
    v_mfma_f32_16x16x32_bf16 v[40:43], v[168:171], v[164:167], v[40:43]
    v_mfma_f32_16x16x32_bf16 v[48:51], v[176:179], v[164:167], v[48:51]
    buffer_load_dwordx4 v[140:143], v29, s[60:63], s81 offen offset:0 sc1
    v_mfma_f32_16x16x32_bf16 v[56:59], v[184:187], v[164:167], v[56:59]
    v_mfma_f32_16x16x32_bf16 v[36:39], v[160:163], v[172:175], v[36:39]
    buffer_load_dwordx4 v[148:151], v29, s[60:63], s80 offen offset:1024 sc1
    v_mfma_f32_16x16x32_bf16 v[44:47], v[168:171], v[172:175], v[44:47]
    v_mfma_f32_16x16x32_bf16 v[52:55], v[176:179], v[172:175], v[52:55]
    buffer_load_dwordx4 v[156:159], v29, s[60:63], s81 offen offset:1024 sc1
    v_mfma_f32_16x16x32_bf16 v[60:63], v[184:187], v[172:175], v[60:63]
    s_waitcnt vmcnt(8)
    s_mov_b64 exec, 1
    buffer_store_dword v0, v27, s[60:63], s85 offen offset:64
    s_mov_b64 exec, -1
    v_mfma_f32_16x16x32_bf16 v[32:35], v[192:195], v[180:183], v[32:35]
    v_mfma_f32_16x16x32_bf16 v[40:43], v[200:203], v[180:183], v[40:43]
    v_mfma_f32_16x16x32_bf16 v[48:51], v[208:211], v[180:183], v[48:51]
    v_mfma_f32_16x16x32_bf16 v[56:59], v[216:219], v[180:183], v[56:59]
    v_mfma_f32_16x16x32_bf16 v[36:39], v[192:195], v[188:191], v[36:39]
    v_mfma_f32_16x16x32_bf16 v[44:47], v[200:203], v[188:191], v[44:47]
    v_mfma_f32_16x16x32_bf16 v[52:55], v[208:211], v[188:191], v[52:55]
    v_mfma_f32_16x16x32_bf16 v[60:63], v[216:219], v[188:191], v[60:63]
    s_waitcnt vmcnt(6) lgkmcnt(0)
    s_barrier
    s_lshl_b32 s86, 1, s7
    s_cmp_eq_u32 s3, 0
    s_cselect_b32 exec_lo, s86, 0
    s_mov_b32 exec_hi, 0
    buffer_store_dword v0, v27, s[60:63], s24 offen offset:32 sc1
    s_mov_b64 exec, -1
    v_mfma_f32_16x16x32_bf16 v[64:67], v[228:231], v[196:199], 0
    ds_read_b64_tr_b16 v[112:113], v8 offset:0
    ds_read_b64_tr_b16 v[114:115], v8 offset:4096
    v_mfma_f32_16x16x32_bf16 v[72:75], v[236:239], v[196:199], 0
    ds_read_b64_tr_b16 v[116:117], v9 offset:0
    ds_read_b64_tr_b16 v[118:119], v9 offset:4096
    v_mfma_f32_16x16x32_bf16 v[80:83], v[244:247], v[196:199], 0
    ds_read_b64_tr_b16 v[120:121], v10 offset:0
    ds_read_b64_tr_b16 v[122:123], v10 offset:4096
    v_mfma_f32_16x16x32_bf16 v[88:91], v[252:255], v[196:199], 0
    ds_read_b64_tr_b16 v[124:125], v11 offset:0
    ds_read_b64_tr_b16 v[126:127], v11 offset:4096
    v_mfma_f32_16x16x32_bf16 v[68:71], v[228:231], v[204:207], 0
    v_mfma_f32_16x16x32_bf16 v[76:79], v[236:239], v[204:207], 0
    v_mfma_f32_16x16x32_bf16 v[84:87], v[244:247], v[204:207], 0
    v_mfma_f32_16x16x32_bf16 v[92:95], v[252:255], v[204:207], 0
    v_mfma_f32_16x16x32_bf16 v[64:67], v[128:131], v[212:215], v[64:67]
    v_mfma_f32_16x16x32_bf16 v[72:75], v[136:139], v[212:215], v[72:75]
    v_mfma_f32_16x16x32_bf16 v[80:83], v[144:147], v[212:215], v[80:83]
    v_mfma_f32_16x16x32_bf16 v[88:91], v[152:155], v[212:215], v[88:91]
    v_mfma_f32_16x16x32_bf16 v[68:71], v[128:131], v[220:223], v[68:71]
    v_mfma_f32_16x16x32_bf16 v[76:79], v[136:139], v[220:223], v[76:79]
    v_mfma_f32_16x16x32_bf16 v[84:87], v[144:147], v[220:223], v[84:87]
    v_mfma_f32_16x16x32_bf16 v[92:95], v[152:155], v[220:223], v[92:95]
    s_waitcnt vmcnt(5)
    v_mfma_f32_16x16x32_bf16 v[32:35], v[224:227], v[132:135], v[32:35]
    ds_read_b64_tr_b16 v[228:229], v8 offset:2048
    ds_read_b64_tr_b16 v[230:231], v8 offset:6144
    buffer_load_dword v28, v27, s[60:63], s84 offen sc1
    v_mfma_f32_16x16x32_bf16 v[40:43], v[232:235], v[132:135], v[40:43]
    ds_read_b64_tr_b16 v[236:237], v9 offset:2048
    ds_read_b64_tr_b16 v[238:239], v9 offset:6144
    v_mfma_f32_16x16x32_bf16 v[48:51], v[240:243], v[132:135], v[48:51]
    ds_read_b64_tr_b16 v[244:245], v10 offset:2048
    ds_read_b64_tr_b16 v[246:247], v10 offset:6144
    buffer_load_dwordx4 v[212:215], v2, s[60:63], s82 offen offset:2048 sc1
    v_mfma_f32_16x16x32_bf16 v[56:59], v[248:251], v[132:135], v[56:59]
    ds_read_b64_tr_b16 v[252:253], v11 offset:2048
    ds_read_b64_tr_b16 v[254:255], v11 offset:6144
    s_waitcnt vmcnt(6)
    v_mfma_f32_16x16x32_bf16 v[36:39], v[224:227], v[140:143], v[36:39]
    ds_read_b64_tr_b16 v[128:129], v8 offset:32768
    ds_read_b64_tr_b16 v[130:131], v8 offset:36864
    buffer_load_dwordx4 v[220:223], v2, s[60:63], s83 offen offset:2048 sc1
    v_mfma_f32_16x16x32_bf16 v[44:47], v[232:235], v[140:143], v[44:47]
    ds_read_b64_tr_b16 v[136:137], v9 offset:32768
    ds_read_b64_tr_b16 v[138:139], v9 offset:36864
    v_mfma_f32_16x16x32_bf16 v[52:55], v[240:243], v[140:143], v[52:55]
    ds_read_b64_tr_b16 v[144:145], v10 offset:32768
    ds_read_b64_tr_b16 v[146:147], v10 offset:36864
    v_mfma_f32_16x16x32_bf16 v[60:63], v[248:251], v[140:143], v[60:63]
    ds_read_b64_tr_b16 v[152:153], v11 offset:32768
    ds_read_b64_tr_b16 v[154:155], v11 offset:36864
    buffer_load_dwordx4 v[132:135], v2, s[60:63], s82 offen offset:3072 sc1
    buffer_load_dwordx4 v[140:143], v2, s[60:63], s83 offen offset:3072 sc1
    s_waitcnt vmcnt(4)
    v_cmp_ne_u32 vcc, s12, v28
    s_nop 0
    s_and_b64 vcc, vcc, s[20:21]
    s_cbranch_scc0 L_ok8
    s_mov_b32 s86, 0
L_sp9:
    s_sleep 1
    buffer_load_dword v28, v27, s[60:63], s84 offen sc1
    s_waitcnt vmcnt(0)
    v_cmp_ne_u32 vcc, s12, v28
    s_nop 0
    s_and_b64 vcc, vcc, s[20:21]
    s_cbranch_scc0 L_ok8
    s_add_u32 s86, s86, 1
    s_and_b32 vcc_lo, s86, 7
    s_cbranch_scc1 L_sp9
    buffer_load_dword v28, v27, s[60:63], s24 offen sc1
    s_waitcnt vmcnt(0)
    v_cmp_ne_u32 vcc, s12, v28
    v_mov_b32 v28, 0
    s_and_b32 vcc_lo, vcc_lo, 0xff00
    s_cbranch_scc0 L_ok8
    s_cmp_lt_u32 s86, 0x100000
    s_cbranch_scc1 L_sp9
L_ok8:
    buffer_load_dwordx4 v[164:167], v29, s[60:63], s80 offen offset:2048 sc1
    buffer_load_dwordx4 v[172:175], v29, s[60:63], s81 offen offset:2048 sc1
    buffer_load_dword v22, v21, s[60:63], s99 offen offset:0 sc1
    buffer_load_dword v23, v21, s[60:63], s99 offen offset:128 sc1
    buffer_load_dword v25, v16, s[60:63], s99 offen offset:0 sc1
    buffer_load_dword v26, v16, s[60:63], s99 offen offset:128 sc1
    buffer_load_dwordx4 v[180:183], v29, s[60:63], s80 offen offset:3072 sc1
    buffer_load_dwordx4 v[188:191], v29, s[60:63], s81 offen offset:3072 sc1
    buffer_load_dwordx4 v[196:199], v31, s[60:63], s80 offen offset:0 sc1
    buffer_load_dwordx4 v[204:207], v31, s[60:63], s81 offen offset:0 sc1
    v_mfma_f32_16x16x32_bf16 v[32:35], v[96:99], v[148:151], v[32:35]
    v_mfma_f32_16x16x32_bf16 v[40:43], v[100:103], v[148:151], v[40:43]
    v_mfma_f32_16x16x32_bf16 v[48:51], v[104:107], v[148:151], v[48:51]
    v_mfma_f32_16x16x32_bf16 v[56:59], v[108:111], v[148:151], v[56:59]
    v_mfma_f32_16x16x32_bf16 v[36:39], v[96:99], v[156:159], v[36:39]
    v_mfma_f32_16x16x32_bf16 v[44:47], v[100:103], v[156:159], v[44:47]
    v_mfma_f32_16x16x32_bf16 v[52:55], v[104:107], v[156:159], v[52:55]
    v_mfma_f32_16x16x32_bf16 v[60:63], v[108:111], v[156:159], v[60:63]
    s_waitcnt vmcnt(9) lgkmcnt(14)
    v_mfma_f32_16x16x32_bf16 v[32:35], v[112:115], v[164:167], v[32:35]
    buffer_load_dwordx4 v[148:151], v29, s[60:63], s82 offen offset:0 sc1
    v_mfma_f32_16x16x32_bf16 v[40:43], v[116:119], v[164:167], v[40:43]
    v_mfma_f32_16x16x32_bf16 v[48:51], v[120:123], v[164:167], v[48:51]
    buffer_load_dwordx4 v[156:159], v29, s[60:63], s83 offen offset:0 sc1
    v_mfma_f32_16x16x32_bf16 v[56:59], v[124:127], v[164:167], v[56:59]
    s_waitcnt vmcnt(10)
    v_mfma_f32_16x16x32_bf16 v[36:39], v[112:115], v[172:175], v[36:39]
    v_mfma_f32_16x16x32_bf16 v[44:47], v[116:119], v[172:175], v[44:47]
    v_mfma_f32_16x16x32_bf16 v[52:55], v[120:123], v[172:175], v[52:55]
    v_mfma_f32_16x16x32_bf16 v[60:63], v[124:127], v[172:175], v[60:63]
    s_waitcnt vmcnt(9)
    v_sub_f32 v22, 1.0, v22
    s_waitcnt vmcnt(8)
    v_sub_f32 v23, 1.0, v23
    s_waitcnt vmcnt(7)
    v_sub_f32 v25, 1.0, v25
    s_waitcnt vmcnt(6)
    v_sub_f32 v26, 1.0, v26
    v_mul_f32 v32, v32, v22
    v_mul_f32 v33, v33, v22
    v_mul_f32 v34, v34, v22
    v_mul_f32 v35, v35, v22
    v_mul_f32 v40, v40, v22
    v_mul_f32 v41, v41, v22
    v_mul_f32 v42, v42, v22
    v_mul_f32 v43, v43, v22
    s_waitcnt vmcnt(5)
    v_mfma_f32_16x16x32_bf16 v[32:35], v[228:231], v[180:183], v[32:35]
    v_mul_f32 v48, v48, v22
    v_mul_f32 v49, v49, v22
    v_mul_f32 v50, v50, v22
    v_mul_f32 v51, v51, v22
    buffer_load_dwordx4 v[164:167], v29, s[60:63], s82 offen offset:1024 sc1
    s_waitcnt lgkmcnt(12)
    v_mfma_f32_16x16x32_bf16 v[40:43], v[236:239], v[180:183], v[40:43]
    v_mul_f32 v56, v56, v22
    v_mul_f32 v57, v57, v22
    v_mul_f32 v58, v58, v22
    v_mul_f32 v59, v59, v22
    s_waitcnt lgkmcnt(10)
    v_mfma_f32_16x16x32_bf16 v[48:51], v[244:247], v[180:183], v[48:51]
    v_mul_f32 v36, v36, v23
    v_mul_f32 v37, v37, v23
    v_mul_f32 v38, v38, v23
    v_mul_f32 v39, v39, v23
    buffer_load_dwordx4 v[172:175], v29, s[60:63], s83 offen offset:1024 sc1
    s_waitcnt lgkmcnt(8)
    v_mfma_f32_16x16x32_bf16 v[56:59], v[252:255], v[180:183], v[56:59]
    v_mul_f32 v44, v44, v23
    v_mul_f32 v45, v45, v23
    v_mul_f32 v46, v46, v23
    v_mul_f32 v47, v47, v23
    s_waitcnt vmcnt(6)
    v_mfma_f32_16x16x32_bf16 v[36:39], v[228:231], v[188:191], v[36:39]
    v_mul_f32 v52, v52, v23
    v_mul_f32 v53, v53, v23
    v_mul_f32 v54, v54, v23
    v_mul_f32 v55, v55, v23
    v_mfma_f32_16x16x32_bf16 v[44:47], v[236:239], v[188:191], v[44:47]
    v_mul_f32 v60, v60, v23
    v_mul_f32 v61, v61, v23
    v_mul_f32 v62, v62, v23
    v_mul_f32 v63, v63, v23
    v_mfma_f32_16x16x32_bf16 v[52:55], v[244:247], v[188:191], v[52:55]
    s_nop 0
    v_mfma_f32_16x16x32_bf16 v[60:63], v[252:255], v[188:191], v[60:63]
    s_waitcnt vmcnt(5) lgkmcnt(4)
    v_mfma_f32_16x16x32_bf16 v[40:43], v[136:139], v[196:199], v[40:43]
    buffer_load_dwordx4 v[180:183], v29, s[60:63], s82 offen offset:2048 sc1
    s_waitcnt lgkmcnt(2)
    v_mfma_f32_16x16x32_bf16 v[48:51], v[144:147], v[196:199], v[48:51]
    s_waitcnt lgkmcnt(0)
    v_mfma_f32_16x16x32_bf16 v[56:59], v[152:155], v[196:199], v[56:59]
    buffer_load_dwordx4 v[188:191], v29, s[60:63], s83 offen offset:2048 sc1
    s_waitcnt vmcnt(6)
    v_mfma_f32_16x16x32_bf16 v[44:47], v[136:139], v[204:207], v[44:47]
    v_mfma_f32_16x16x32_bf16 v[52:55], v[144:147], v[204:207], v[52:55]
    v_mfma_f32_16x16x32_bf16 v[60:63], v[152:155], v[204:207], v[60:63]
    v_mfma_f32_16x16x32_bf16 v[32:35], v[128:131], v[196:199], v[32:35]
    v_mfma_f32_16x16x32_bf16 v[36:39], v[128:131], v[204:207], v[36:39]
    v_mfma_f32_16x16x32_bf16 v[64:67], v[160:163], v[212:215], v[64:67]
    ds_write_b128 v17, v[40:43] offset:0
    s_nop 1
    ds_write_b128 v17, v[44:47] offset:1024
    buffer_load_dwordx4 v[196:199], v29, s[60:63], s82 offen offset:3072 sc1
    v_mfma_f32_16x16x32_bf16 v[72:75], v[168:171], v[212:215], v[72:75]
    ds_write_b128 v18, v[48:51] offset:16384
    ds_write_b128 v18, v[52:55] offset:17408
    v_mfma_f32_16x16x32_bf16 v[80:83], v[176:179], v[212:215], v[80:83]
    ds_write_b128 v19, v[56:59] offset:32768
    ds_write_b128 v19, v[60:63] offset:33792
    buffer_load_dwordx4 v[204:207], v29, s[60:63], s83 offen offset:3072 sc1
    v_mfma_f32_16x16x32_bf16 v[88:91], v[184:187], v[212:215], v[88:91]
    v_mfma_f32_16x16x32_bf16 v[68:71], v[160:163], v[220:223], v[68:71]
    v_mfma_f32_16x16x32_bf16 v[76:79], v[168:171], v[220:223], v[76:79]
    v_mfma_f32_16x16x32_bf16 v[84:87], v[176:179], v[220:223], v[84:87]
    v_mfma_f32_16x16x32_bf16 v[92:95], v[184:187], v[220:223], v[92:95]
    s_waitcnt lgkmcnt(0)
    s_barrier
    ds_read_b128 v[40:43], v20 offset:0
    ds_read_b128 v[44:47], v20 offset:1024
    ds_read_b128 v[48:51], v20 offset:16384
    ds_read_b128 v[52:55], v20 offset:17408
    ds_read_b128 v[56:59], v20 offset:32768
    ds_read_b128 v[60:63], v20 offset:33792
    v_mfma_f32_16x16x32_bf16 v[64:67], v[192:195], v[132:135], v[64:67]
    s_mov_b32 s13, 0x07060501
    s_mov_b32 s14, 0x07060502
    s_mov_b32 s15, 0x07060503
    s_waitcnt lgkmcnt(5)
    v_add_f32 v32, v32, v40
    buffer_load_dwordx4 v[212:215], v31, s[60:63], s82 offen offset:0 sc1
    v_mfma_f32_16x16x32_bf16 v[72:75], v[200:203], v[132:135], v[72:75]
    v_add_f32 v33, v33, v41
    v_add_f32 v34, v34, v42
    v_add_f32 v35, v35, v43
    s_waitcnt lgkmcnt(1)
    v_add_f32 v48, v48, v56
    v_mfma_f32_16x16x32_bf16 v[80:83], v[208:211], v[132:135], v[80:83]
    v_add_f32 v49, v49, v57
    v_add_f32 v50, v50, v58
    v_add_f32 v51, v51, v59
    v_add_f32 v32, v32, v48
    buffer_load_dwordx4 v[220:223], v31, s[60:63], s83 offen offset:0 sc1
    v_mfma_f32_16x16x32_bf16 v[88:91], v[216:219], v[132:135], v[88:91]
    v_add_f32 v33, v33, v49
    v_add_f32 v34, v34, v50
    v_add_f32 v35, v35, v51
    v_perm_b32 v40, v32, v35, s13
    v_mfma_f32_16x16x32_bf16 v[68:71], v[192:195], v[140:143], v[68:71]
    v_perm_b32 v41, v33, v35, s14
    v_perm_b32 v42, v34, v35, s15
    v_mov_b32 v43, s12
    v_add_f32 v36, v36, v44
    v_mfma_f32_16x16x32_bf16 v[76:79], v[200:203], v[140:143], v[76:79]
    v_add_f32 v37, v37, v45
    v_add_f32 v38, v38, v46
    v_add_f32 v39, v39, v47
    s_waitcnt lgkmcnt(0)
    v_add_f32 v52, v52, v60
    v_mfma_f32_16x16x32_bf16 v[84:87], v[208:211], v[140:143], v[84:87]
    v_add_f32 v53, v53, v61
    v_add_f32 v54, v54, v62
    v_add_f32 v55, v55, v63
    v_add_f32 v36, v36, v52
    v_mfma_f32_16x16x32_bf16 v[92:95], v[216:219], v[140:143], v[92:95]
    v_add_f32 v37, v37, v53
    v_add_f32 v38, v38, v54
    v_add_f32 v39, v39, v55
    v_perm_b32 v44, v36, v39, s13
    v_perm_b32 v45, v37, v39, s14
    v_perm_b32 v46, v38, v39, s15
    v_mov_b32 v47, s12
    v_add_u32 v17, 65536, v17
    v_add_u32 v18, 65536, v18
    v_add_u32 v19, 65536, v19
    v_add_u32 v20, 65536, v20
    buffer_store_dwordx4 v[40:43], v2, s[60:63], s98 offen offset:0 sc1
    buffer_store_dwordx4 v[44:47], v2, s[60:63], s98 offen offset:1024 sc1
    s_waitcnt vmcnt(11)
    v_mfma_f32_16x16x32_bf16 v[64:67], v[224:227], v[148:151], v[64:67]
    v_mfma_f32_16x16x32_bf16 v[72:75], v[232:235], v[148:151], v[72:75]
    v_mfma_f32_16x16x32_bf16 v[80:83], v[240:243], v[148:151], v[80:83]
    v_mfma_f32_16x16x32_bf16 v[88:91], v[248:251], v[148:151], v[88:91]
    s_waitcnt vmcnt(10)
    v_mfma_f32_16x16x32_bf16 v[68:71], v[224:227], v[156:159], v[68:71]
    v_mfma_f32_16x16x32_bf16 v[76:79], v[232:235], v[156:159], v[76:79]
    v_mfma_f32_16x16x32_bf16 v[84:87], v[240:243], v[156:159], v[84:87]
    v_mfma_f32_16x16x32_bf16 v[92:95], v[248:251], v[156:159], v[92:95]
    s_waitcnt vmcnt(9)
    v_mfma_f32_16x16x32_bf16 v[64:67], v[96:99], v[164:167], v[64:67]
    v_lshlrev_b32 v168, 16, v14
    v_and_b32 v169, 0xffff0000, v14
    v_mfma_f32_16x16x32_bf16 v[72:75], v[100:103], v[164:167], v[72:75]
    v_lshlrev_b32 v170, 16, v15
    v_and_b32 v171, 0xffff0000, v15
    v_mfma_f32_16x16x32_bf16 v[80:83], v[104:107], v[164:167], v[80:83]
    v_mfma_f32_16x16x32_bf16 v[88:91], v[108:111], v[164:167], v[88:91]
    s_waitcnt vmcnt(8)
    v_mfma_f32_16x16x32_bf16 v[68:71], v[96:99], v[172:175], v[68:71]
    v_mfma_f32_16x16x32_bf16 v[76:79], v[100:103], v[172:175], v[76:79]
    v_mfma_f32_16x16x32_bf16 v[84:87], v[104:107], v[172:175], v[84:87]
    v_mfma_f32_16x16x32_bf16 v[92:95], v[108:111], v[172:175], v[92:95]
    s_waitcnt vmcnt(7)
    v_mfma_f32_16x16x32_bf16 v[64:67], v[112:115], v[180:183], v[64:67]
    v_mfma_f32_16x16x32_bf16 v[72:75], v[116:119], v[180:183], v[72:75]
    v_mfma_f32_16x16x32_bf16 v[80:83], v[120:123], v[180:183], v[80:83]
    v_mfma_f32_16x16x32_bf16 v[88:91], v[124:127], v[180:183], v[88:91]
    s_waitcnt vmcnt(6)
    v_mfma_f32_16x16x32_bf16 v[68:71], v[112:115], v[188:191], v[68:71]
    v_mfma_f32_16x16x32_bf16 v[76:79], v[116:119], v[188:191], v[76:79]
    v_mfma_f32_16x16x32_bf16 v[84:87], v[120:123], v[188:191], v[84:87]
    v_mfma_f32_16x16x32_bf16 v[92:95], v[124:127], v[188:191], v[92:95]
    v_mul_f32 v64, v64, v25
    v_mul_f32 v65, v65, v25
    v_mul_f32 v66, v66, v25
    v_mul_f32 v67, v67, v25
    v_mul_f32 v72, v72, v25
    v_mul_f32 v73, v73, v25
    v_mul_f32 v74, v74, v25
    v_mul_f32 v75, v75, v25
    s_waitcnt vmcnt(5)
    v_mfma_f32_16x16x32_bf16 v[64:67], v[228:231], v[196:199], v[64:67]
    v_mul_f32 v80, v80, v25
    v_mul_f32 v81, v81, v25
    v_mul_f32 v82, v82, v25
    v_mul_f32 v83, v83, v25
    v_mfma_f32_16x16x32_bf16 v[72:75], v[236:239], v[196:199], v[72:75]
    v_mul_f32 v88, v88, v25
    v_mul_f32 v89, v89, v25
    v_mul_f32 v90, v90, v25
    v_mul_f32 v91, v91, v25
    v_mfma_f32_16x16x32_bf16 v[80:83], v[244:247], v[196:199], v[80:83]
    v_mul_f32 v68, v68, v26
    v_mul_f32 v69, v69, v26
    v_mul_f32 v70, v70, v26
    v_mul_f32 v71, v71, v26
    v_mfma_f32_16x16x32_bf16 v[88:91], v[252:255], v[196:199], v[88:91]
    v_mul_f32 v76, v76, v26
    v_mul_f32 v77, v77, v26
    v_mul_f32 v78, v78, v26
    v_mul_f32 v79, v79, v26
    s_waitcnt vmcnt(3)
    v_mfma_f32_16x16x32_bf16 v[72:75], v[136:139], v[212:215], v[72:75]
    v_mul_f32 v84, v84, v26
    v_mul_f32 v85, v85, v26
    v_mul_f32 v86, v86, v26
    v_mul_f32 v87, v87, v26
    v_mfma_f32_16x16x32_bf16 v[80:83], v[144:147], v[212:215], v[80:83]
    v_mul_f32 v92, v92, v26
    v_mul_f32 v93, v93, v26
    v_mul_f32 v94, v94, v26
    v_mul_f32 v95, v95, v26
    v_mfma_f32_16x16x32_bf16 v[88:91], v[152:155], v[212:215], v[88:91]
    v_mfma_f32_16x16x32_bf16 v[64:67], v[128:131], v[212:215], v[64:67]
    v_mfma_f32_16x16x32_bf16 v[68:71], v[228:231], v[204:207], v[68:71]
    s_nop 0
    s_nop 0
    v_mfma_f32_16x16x32_bf16 v[76:79], v[236:239], v[204:207], v[76:79]
    s_nop 0
    s_nop 0
    v_mfma_f32_16x16x32_bf16 v[84:87], v[244:247], v[204:207], v[84:87]
    ds_write_b128 v17, v[72:75] offset:0
    ds_write_b128 v18, v[80:83] offset:16384
    v_mfma_f32_16x16x32_bf16 v[92:95], v[252:255], v[204:207], v[92:95]
    ds_write_b128 v19, v[88:91] offset:32768
    s_waitcnt vmcnt(2)
    v_mfma_f32_16x16x32_bf16 v[76:79], v[136:139], v[220:223], v[76:79]
    v_mfma_f32_16x16x32_bf16 v[84:87], v[144:147], v[220:223], v[84:87]
    v_mfma_f32_16x16x32_bf16 v[92:95], v[152:155], v[220:223], v[92:95]
    v_mfma_f32_16x16x32_bf16 v[68:71], v[128:131], v[220:223], v[68:71]
    s_nop 4
    ds_write_b128 v17, v[76:79] offset:1024
    ds_write_b128 v18, v[84:87] offset:17408
    ds_write_b128 v19, v[92:95] offset:33792
    s_xor_b32 s98, s98, 0x8000
    buffer_load_dwordx4 v[192:195], v2, s[60:63], s98 offen offset:0 sc1
    buffer_load_dwordx4 v[200:203], v2, s[60:63], s98 offen offset:1024 sc1
    v_fma_f32 v64, v168, v25, v64
    v_fma_f32 v65, v169, v25, v65
    v_fma_f32 v66, v170, v25, v66
    v_fma_f32 v67, v171, v25, v67
    v_fma_f32 v68, v168, v26, v68
    v_fma_f32 v69, v169, v26, v69
    v_fma_f32 v70, v170, v26, v70
    v_fma_f32 v71, v171, v26, v71
    s_mov_b32 s13, 0x4000
    s_waitcnt lgkmcnt(0)
    s_barrier
    ds_read_b128 v[72:75], v20 offset:0
    ds_read_b128 v[80:83], v20 offset:16384
    ds_read_b128 v[88:91], v20 offset:32768
    ds_read_b128 v[76:79], v20 offset:1024
    ds_read_b128 v[84:87], v20 offset:17408
    ds_read_b128 v[92:95], v20 offset:33792
    s_waitcnt lgkmcnt(5)
    v_add_f32 v64, v64, v72
    v_add_f32 v65, v65, v73
    v_add_f32 v66, v66, v74
    v_add_f32 v67, v67, v75
    s_waitcnt lgkmcnt(3)
    v_add_f32 v80, v80, v88
    v_add_f32 v81, v81, v89
    v_add_f32 v82, v82, v90
    v_add_f32 v83, v83, v91
    v_add_f32 v64, v64, v80
    v_add_f32 v65, v65, v81
    v_add_f32 v66, v66, v82
    v_add_f32 v67, v67, v83
    s_waitcnt lgkmcnt(2)
    v_add_f32 v68, v68, v76
    v_add_f32 v69, v69, v77
    v_add_f32 v70, v70, v78
    v_add_f32 v71, v71, v79
    s_waitcnt lgkmcnt(0)
    v_add_f32 v84, v84, v92
    v_add_f32 v85, v85, v93
    v_add_f32 v86, v86, v94
    v_add_f32 v87, v87, v95
    v_add_f32 v68, v68, v84
    v_add_f32 v69, v69, v85
    v_add_f32 v70, v70, v86
    v_add_f32 v71, v71, v87
    s_waitcnt vmcnt(1)
    v_xor_b32 v24, s12, v195
    s_waitcnt vmcnt(0)
    v_xor_b32 v22, s12, v203
    v_or_b32 v24, v24, v22
    v_cmp_ne_u32 vcc, 0, v24
    s_nop 1
    s_cbranch_vccz L_ok10
    s_mov_b32 s86, 0
L_sp11:
    buffer_load_dwordx4 v[192:195], v2, s[60:63], s98 offen offset:0 sc1
    buffer_load_dwordx4 v[200:203], v2, s[60:63], s98 offen offset:1024 sc1
    s_mov_b64 exec, -1
    s_waitcnt vmcnt(0)
    v_xor_b32 v24, s12, v195
    v_xor_b32 v22, s12, v203
    v_or_b32 v24, v24, v22
    v_cmp_ne_u32 vcc, 0, v24
    s_nop 1
    s_cbranch_vccz L_ok10
    s_sleep 1
    s_add_u32 s86, s86, 1
    s_cmp_lt_u32 s86, 0x100000
    s_cbranch_scc1 L_sp11
L_ok10:
    s_mov_b32 s14, 0x0c04000c
    s_mov_b32 s15, 0x04020100
    v_perm_b32 v195, v193, v192, s14
    v_perm_b32 v195, v194, v195, s15
    v_add_f32 v64, v64, v192
    v_add_f32 v65, v65, v193
    v_add_f32 v66, v66, v194
    v_add_f32 v67, v67, v195
    v_cvt_pk_bf16_f32 v176, v64, v65
    v_cvt_pk_bf16_f32 v177, v66, v67
    buffer_store_dwordx2 v[176:177], v12, s[64:67], 0 offen
    v_perm_b32 v203, v201, v200, s14
    v_perm_b32 v203, v202, v203, s15
    v_add_f32 v68, v68, v200
    v_add_f32 v69, v69, v201
    v_add_f32 v70, v70, v202
    v_add_f32 v71, v71, v203
    v_cvt_pk_bf16_f32 v178, v68, v69
    v_cvt_pk_bf16_f32 v179, v70, v71
    buffer_store_dwordx2 v[178:179], v12, s[64:67], s13 offen
    s_endpgm
L_roleQ:
    s_waitcnt lgkmcnt(0)
    global_load_dwordx2 v[88:89], v26, s[26:27] offset:0
    global_load_dwordx2 v[90:91], v26, s[26:27] offset:32
    global_load_dwordx2 v[92:93], v26, s[26:27] offset:128
    global_load_dwordx2 v[94:95], v26, s[26:27] offset:160
    s_sub_u32 s40, s16, 4096
    s_subb_u32 s41, s17, 0
    buffer_load_dwordx4 v17, s[40:43], s69 offen offset:0  lds
    buffer_load_dwordx4 v18, s[40:43], s69 offen offset:1024  lds
    s_sub_u32 s44, s18, 4096
    s_subb_u32 s45, s19, 0
    s_sub_u32 s48, s24, 4096
    s_subb_u32 s49, s25, 0
    s_cmp_ge_u32 s2, 128
    s_cselect_b64 s[52:53], s[48:49], s[44:45]
    buffer_load_dwordx4 v19, s[52:55], s78 offen offset:2048  lds
    buffer_load_dwordx4 v20, s[52:55], s78 offen offset:3072  lds
    s_getpc_b64 s[74:75]
    s_bfe_u32 s15, s2, 0x40003
    s_lshl_b32 s15, s15, 10
    v_lshl_add_u32 v26, v1, 7, s15
    s_mov_b32 m0, 133120
    s_cmp_eq_u32 s3, 6
    s_cselect_b64 exec, 0xff, 0
    global_load_lds_dword v26, s[74:75]
    s_mov_b64 exec, -1
    v_add_u32 v26, s69, v2
    s_mov_b32 m0, 131072
    v_and_b32 v26, 0x3ff, v26
    s_cmp_eq_u32 s3, 7
    s_cselect_b64 exec, -1, 0
    global_load_lds_dwordx4 v26, s[32:33]
    s_mov_b64 exec, -1
    s_sub_u32 s52, s28, 4096
    s_subb_u32 s53, s29, 0
    s_sub_u32 s56, s20, 4096
    s_subb_u32 s57, s21, 0
    s_mov_b64 s[60:61], s[38:39]
    s_mov_b32 s54, 0x1c1000
    s_mov_b32 s55, 0x20000
    s_mov_b32 s58, 0x81000
    s_mov_b32 s59, 0x20000
    s_mov_b32 s62, 0x10000000
    s_mov_b32 s63, 0x20000
    v_mul_u32_u24 v26, 3072, v25
    v_add3_u32 v21, v26, v24, s14
    s_lshl1_add_u32 s13, s5, s4
    v_lshlrev_b32 v27, 2, v1
    s_lshl_b32 s24, s13, 9
    s_lshl_b32 s15, s7, 5
    s_add_u32 s24, s24, 0x20000
    s_add_u32 s15, s15, s3
    s_add_u32 s84, s24, 0x10000
    s_lshl2_add_u32 s85, s15, s84
    s_lshr_b32 s15, s3, 2
    s_lshl_b32 s15, s15, 8
    s_add_u32 s84, s84, s15
    s_lshl2_add_u32 s99, s13, s10
    s_lshl2_add_u32 s99, s99, s11
    s_lshl_b32 s99, s99, 8
    s_add_u32 s99, s99, 0x40000
    s_lshl_b32 s13, s11, 1
    s_and_b32 s15, s3, 2
    s_lshl_b32 s18, 0x330000, s13
    s_lshl4_add_u32 s15, s15, s13
    s_mov_b32 s19, s18
    s_lshl_b64 s[16:17], 0x33, s15
    s_lshl_b64 s[20:21], s[16:17], 24
    s_or_b64 s[20:21], s[20:21], s[18:19]
    s_lshl_b64 s[18:19], s[16:17], 8
    s_mov_b64 s[64:65], s[34:35]
    s_mov_b32 s66, 0x200000
    s_mov_b32 s67, 0x20000
    v_mul_u32_u24 v82, 3072, v1
    s_lshl_b32 s13, s6, 7
    s_add_u32 s13, s13, 4096
    v_lshl_add_u32 v83, v1, 10, s13
    s_mul_i32 s13, s5, 98304
    s_add_u32 s13, s13, 4096
    s_add_u32 s34, s13, s14
    v_and_b32 v24, 15, v1
    v_lshrrev_b32 v25, 1, v24
    v_xor_b32 v25, v25, v3
    v_lshlrev_b32 v25, 4, v25
    s_lshl_b32 s13, s87, 12
    v_lshl_add_u32 v25, v24, 7, v25
    v_add_u32 v4, s13, v25
    v_xor_b32 v5, 64, v4
    v_xor_b32 v6, 0x1000, v4
    v_xor_b32 v7, 0x1000, v5
    v_add_u32 v8, 0x10000, v4
    v_add_u32 v9, 0x10000, v5
    v_add_u32 v10, 0x10000, v6
    v_add_u32 v11, 0x10000, v7
    v_bfe_u32 v24, v1, 2, 2
    v_and_b32 v25, 3, v29
    v_and_b32 v26, 3, v1
    v_lshlrev_b32 v26, 3, v26
    v_lshl_add_u32 v31, v25, 5, v26
    v_lshl_add_u32 v26, v24, 7, v31
    v_lshl_add_u32 v26, v3, 12, v26
    s_lshl_b32 s13, s11, 6
    v_xor_b32 v12, s13, v26
    v_xor_b32 v13, 32, v12
    v_add_u32 v14, 0x10000, v12
    v_add_u32 v15, 0x10000, v13
    s_mov_b32 s23, 0x358637bd
    s_mov_b32 s22, 0x3fb8aa3b
    v_mov_b32 v26, 0xb5c1a2a0
    v_lshlrev_b32 v24, 1, v3
    s_lshl_b32 s13, s11, 14
    v_xor_b32 v24, v30, v24
    s_lshl_b32 s14, s6, 7
    v_lshlrev_b32 v24, 4, v24
    s_add_u32 s13, s13, s14
    v_lshl_add_u32 v24, v29, 10, v24
    v_add_u32 v23, s13, v24
    s_lshl2_add_u32 s15, s4, s10
    s_and_b32 s14, s10, 1
    s_lshr_b32 s13, s15, 1
    s_lshl_b32 s77, s15, 16
    s_mul_i32 s13, s13, 7
    s_add_u32 s15, s13, s14
    s_lshl_b32 s75, s15, 16
    s_add_u32 s15, s15, s14
    s_lshl_b32 s74, s15, 16
    s_lshl1_add_u32 s13, s13, s14
    s_lshl_b32 s76, s13, 15
    s_lshl4_add_u32 s13, s4, s5
    s_lshl_b32 s13, s13, 3
    s_add_u32 s14, s13, s87
    s_xor_b32 s15, s14, 1
    s_mul_i32 s72, s14, 36864
    s_mul_i32 s73, s15, 36864
    s_mul_i32 s14, s7, 9
    s_add_u32 s14, s14, s11
    s_lshl_b32 s14, s14, 10
    s_add_u32 s14, s14, 0x400000
    s_add_u32 s72, s72, s14
    s_add_u32 s73, s73, s14
    s_lshl1_add_u32 s13, s11, s13
    s_lshl2_add_u32 s13, s4, s13
    s_xor_b32 s14, s13, 4
    s_mul_i32 s15, s10, 9216
    s_add_u32 s15, s15, 0x400000
    s_mul_i32 s14, s14, 36864
    s_mul_i32 s13, s13, 36864
    s_add_u32 s80, s14, s15
    s_add_u32 s82, s13, s15
    s_add_u32 s81, s80, 36864
    s_add_u32 s83, s82, 36864
    s_lshl3_add_u32 s98, s2, s3
    s_lshl_b32 s98, s98, 12
    s_add_u32 s98, s98, 0x1000000
    v_mov_b32 v30, 0
    v_lshlrev_b32 v16, 4, v3
    v_add_u32 v16, 131072, v16
    s_waitcnt vmcnt(9)
    v_lshlrev_b32 v64, 16, v88
    v_and_b32 v65, 0xffff0000, v88
    v_lshlrev_b32 v66, 16, v89
    v_and_b32 v67, 0xffff0000, v89
    s_waitcnt vmcnt(8)
    v_lshlrev_b32 v68, 16, v90
    v_and_b32 v69, 0xffff0000, v90
    v_lshlrev_b32 v70, 16, v91
    v_and_b32 v71, 0xffff0000, v91
    s_waitcnt vmcnt(7)
    v_lshlrev_b32 v72, 16, v92
    v_and_b32 v73, 0xffff0000, v92
    v_lshlrev_b32 v74, 16, v93
    v_and_b32 v75, 0xffff0000, v93
    s_waitcnt vmcnt(6)
    v_lshlrev_b32 v76, 16, v94
    v_and_b32 v77, 0xffff0000, v94
    v_lshlrev_b32 v78, 16, v95
    v_and_b32 v79, 0xffff0000, v95
    s_add_u32 m0, s68, 32768
    s_add_u32 s69, s69, 128
    s_and_b32 s69, s69, 0x3ff
    buffer_load_dwordx4 v17, s[40:43], s69 offen offset:0  lds
    buffer_load_dwordx4 v18, s[40:43], s69 offen offset:1024  lds
    s_mul_i32 s78, s69, 1792
    buffer_load_dwordx4 v19, s[48:51], s78 offen offset:2048  lds
    buffer_load_dwordx4 v20, s[48:51], s78 offen offset:3072  lds
    s_waitcnt vmcnt(6)
    s_barrier
    ds_read_b128 v[128:131], v4 offset:0
    ds_read_b64_tr_b16 v[96:97], v12 offset:2048
    ds_read_b64_tr_b16 v[98:99], v12 offset:2560
    ds_read_b128 v[132:135], v6 offset:0
    ds_read_b64_tr_b16 v[100:101], v13 offset:2048
    ds_read_b64_tr_b16 v[102:103], v13 offset:2560
    ds_read_b64_tr_b16 v[104:105], v12 offset:3072
    ds_read_b64_tr_b16 v[106:107], v12 offset:3584
    ds_read_b64_tr_b16 v[108:109], v13 offset:3072
    ds_read_b64_tr_b16 v[110:111], v13 offset:3584
    s_add_u32 m0, s68, 65536
    s_add_u32 s69, s69, 128
    s_and_b32 s69, s69, 0x3ff
    buffer_load_dwordx4 v17, s[40:43], s69 offen offset:0  lds
    buffer_load_dwordx4 v18, s[40:43], s69 offen offset:1024  lds
    s_waitcnt lgkmcnt(0)
    v_mfma_f32_16x16x32_bf16 v[32:35], v[96:99], v[128:131], v[64:67]
    v_mfma_f32_16x16x32_bf16 v[36:39], v[96:99], v[132:135], v[64:67]
    v_mfma_f32_16x16x32_bf16 v[40:43], v[100:103], v[128:131], v[68:71]
    s_mul_i32 s78, s69, 1792
    buffer_load_dwordx4 v19, s[48:51], s78 offen offset:2048  lds
    v_mfma_f32_16x16x32_bf16 v[44:47], v[100:103], v[132:135], v[68:71]
    ds_read_b128 v[136:139], v5 offset:0
    ds_read_b64_tr_b16 v[112:113], v12 offset:18432
    ds_read_b64_tr_b16 v[114:115], v12 offset:18944
    v_mfma_f32_16x16x32_bf16 v[48:51], v[104:107], v[128:131], v[72:75]
    ds_read_b128 v[140:143], v7 offset:0
    ds_read_b64_tr_b16 v[116:117], v13 offset:18432
    ds_read_b64_tr_b16 v[118:119], v13 offset:18944
    v_mfma_f32_16x16x32_bf16 v[52:55], v[104:107], v[132:135], v[72:75]
    ds_read_b64_tr_b16 v[120:121], v12 offset:19456
    ds_read_b64_tr_b16 v[122:123], v12 offset:19968
    ds_read_b64_tr_b16 v[124:125], v13 offset:19456
    buffer_load_dwordx4 v20, s[48:51], s78 offen offset:3072  lds
    v_mfma_f32_16x16x32_bf16 v[56:59], v[108:111], v[128:131], v[76:79]
    ds_read_b64_tr_b16 v[126:127], v13 offset:19968
    v_mfma_f32_16x16x32_bf16 v[60:63], v[108:111], v[132:135], v[76:79]
    s_waitcnt vmcnt(4) lgkmcnt(0)
    s_barrier
    ds_read_b128 v[144:147], v4 offset:32768
    ds_read_b64_tr_b16 v[96:97], v12 offset:34816
    v_mfma_f32_16x16x32_bf16 v[32:35], v[112:115], v[136:139], v[32:35]
    ds_read_b64_tr_b16 v[98:99], v12 offset:35328
    ds_read_b128 v[148:151], v6 offset:32768
    v_mov_b32 v76, s23
    s_add_u32 m0, s68, 98304
    s_add_u32 s69, s69, 128
    s_and_b32 s69, s69, 0x3ff
    buffer_load_dwordx4 v17, s[40:43], s69 offen offset:0  lds
    v_mfma_f32_16x16x32_bf16 v[36:39], v[112:115], v[140:143], v[36:39]
    ds_read_b64_tr_b16 v[100:101], v13 offset:34816
    ds_read_b64_tr_b16 v[102:103], v13 offset:35328
    v_mov_b32 v77, s23
    v_mfma_f32_16x16x32_bf16 v[40:43], v[116:119], v[136:139], v[40:43]
    ds_read_b64_tr_b16 v[104:105], v12 offset:35840
    ds_read_b64_tr_b16 v[106:107], v12 offset:36352
    v_mov_b32 v78, s23
    v_mfma_f32_16x16x32_bf16 v[44:47], v[116:119], v[140:143], v[44:47]
    ds_read_b64_tr_b16 v[108:109], v13 offset:35840
    ds_read_b64_tr_b16 v[110:111], v13 offset:36352
    v_mov_b32 v79, s23
    buffer_load_dwordx4 v18, s[40:43], s69 offen offset:1024  lds
    v_mfma_f32_16x16x32_bf16 v[48:51], v[120:123], v[136:139], v[48:51]
    v_mfma_f32_16x16x32_bf16 v[52:55], v[120:123], v[140:143], v[52:55]
    v_mfma_f32_16x16x32_bf16 v[56:59], v[124:127], v[136:139], v[56:59]
    s_mul_i32 s78, s69, 1792
    buffer_load_dwordx4 v19, s[48:51], s78 offen offset:2048  lds
    v_mfma_f32_16x16x32_bf16 v[60:63], v[124:127], v[140:143], v[60:63]
    s_waitcnt lgkmcnt(0)
    ds_read_b128 v[152:155], v5 offset:32768
    ds_read_b64_tr_b16 v[112:113], v12 offset:51200
    v_mfma_f32_16x16x32_bf16 v[32:35], v[96:99], v[144:147], v[32:35]
    ds_read_b64_tr_b16 v[114:115], v12 offset:51712
    ds_read_b128 v[156:159], v7 offset:32768
    v_mfma_f32_16x16x32_bf16 v[36:39], v[96:99], v[148:151], v[36:39]
    ds_read_b64_tr_b16 v[116:117], v13 offset:51200
    ds_read_b64_tr_b16 v[118:119], v13 offset:51712
    buffer_load_dwordx4 v20, s[48:51], s78 offen offset:3072  lds
    v_mfma_f32_16x16x32_bf16 v[40:43], v[100:103], v[144:147], v[40:43]
    ds_read_b64_tr_b16 v[120:121], v12 offset:52224
    ds_read_b64_tr_b16 v[122:123], v12 offset:52736
    v_mfma_f32_16x16x32_bf16 v[44:47], v[100:103], v[148:151], v[44:47]
    ds_read_b64_tr_b16 v[124:125], v13 offset:52224
    ds_read_b64_tr_b16 v[126:127], v13 offset:52736
    v_mfma_f32_16x16x32_bf16 v[48:51], v[104:107], v[144:147], v[48:51]
    s_add_u32 m0, s68, 0
    s_add_u32 s69, s69, 128
    s_and_b32 s69, s69, 0x3ff
    buffer_load_dwordx4 v17, s[40:43], s69 offen offset:0  lds
    v_mfma_f32_16x16x32_bf16 v[52:55], v[104:107], v[148:151], v[52:55]
    v_mfma_f32_16x16x32_bf16 v[56:59], v[108:111], v[144:147], v[56:59]
    v_mfma_f32_16x16x32_bf16 v[60:63], v[108:111], v[148:151], v[60:63]
    buffer_load_dwordx4 v18, s[40:43], s69 offen offset:1024  lds
    s_waitcnt vmcnt(6) lgkmcnt(0)
    s_barrier
    ds_read_b128 v[160:163], v8 offset:0
    ds_read_b64_tr_b16 v[96:97], v14 offset:2048
    v_mfma_f32_16x16x32_bf16 v[32:35], v[112:115], v[152:155], v[32:35]
    ds_read_b64_tr_b16 v[98:99], v14 offset:2560
    ds_read_b128 v[164:167], v10 offset:0
    v_mfma_f32_16x16x32_bf16 v[36:39], v[112:115], v[156:159], v[36:39]
    ds_read_b64_tr_b16 v[100:101], v15 offset:2048
    ds_read_b64_tr_b16 v[102:103], v15 offset:2560
    v_mfma_f32_16x16x32_bf16 v[40:43], v[116:119], v[152:155], v[40:43]
    ds_read_b64_tr_b16 v[104:105], v14 offset:3072
    ds_read_b64_tr_b16 v[106:107], v14 offset:3584
    s_mul_i32 s78, s69, 1792
    buffer_load_dwordx4 v19, s[48:51], s78 offen offset:2048  lds
    v_mfma_f32_16x16x32_bf16 v[44:47], v[116:119], v[156:159], v[44:47]
    ds_read_b64_tr_b16 v[108:109], v15 offset:3072
    ds_read_b64_tr_b16 v[110:111], v15 offset:3584
    v_mfma_f32_16x16x32_bf16 v[48:51], v[120:123], v[152:155], v[48:51]
    v_mfma_f32_16x16x32_bf16 v[52:55], v[120:123], v[156:159], v[52:55]
    buffer_load_dwordx4 v20, s[48:51], s78 offen offset:3072  lds
    v_mfma_f32_16x16x32_bf16 v[56:59], v[124:127], v[152:155], v[56:59]
    v_mfma_f32_16x16x32_bf16 v[60:63], v[124:127], v[156:159], v[60:63]
    s_waitcnt lgkmcnt(0)
    ds_read_b128 v[168:171], v9 offset:0
    ds_read_b64_tr_b16 v[112:113], v14 offset:18432
    v_mfma_f32_16x16x32_bf16 v[32:35], v[96:99], v[160:163], v[32:35]
    ds_read_b64_tr_b16 v[114:115], v14 offset:18944
    ds_read_b128 v[172:175], v11 offset:0
    s_add_u32 m0, s68, 32768
    s_add_u32 s69, s69, 128
    s_and_b32 s69, s69, 0x3ff
    buffer_load_dwordx4 v17, s[40:43], s69 offen offset:0  lds
    v_mfma_f32_16x16x32_bf16 v[36:39], v[96:99], v[164:167], v[36:39]
    ds_read_b64_tr_b16 v[116:117], v15 offset:18432
    ds_read_b64_tr_b16 v[118:119], v15 offset:18944
    v_mfma_f32_16x16x32_bf16 v[40:43], v[100:103], v[160:163], v[40:43]
    ds_read_b64_tr_b16 v[120:121], v14 offset:19456
    ds_read_b64_tr_b16 v[122:123], v14 offset:19968
    v_mfma_f32_16x16x32_bf16 v[44:47], v[100:103], v[164:167], v[44:47]
    ds_read_b64_tr_b16 v[124:125], v15 offset:19456
    ds_read_b64_tr_b16 v[126:127], v15 offset:19968
    buffer_load_dwordx4 v18, s[40:43], s69 offen offset:1024  lds
    v_mfma_f32_16x16x32_bf16 v[48:51], v[104:107], v[160:163], v[48:51]
    v_mfma_f32_16x16x32_bf16 v[52:55], v[104:107], v[164:167], v[52:55]
    v_mfma_f32_16x16x32_bf16 v[56:59], v[108:111], v[160:163], v[56:59]
    s_mul_i32 s78, s69, 1792
    buffer_load_dwordx4 v19, s[48:51], s78 offen offset:2048  lds
    v_mfma_f32_16x16x32_bf16 v[60:63], v[108:111], v[164:167], v[60:63]
    s_waitcnt vmcnt(7) lgkmcnt(0)
    s_barrier
    ds_read_b128 v[176:179], v8 offset:32768
    ds_read_b64_tr_b16 v[96:97], v14 offset:34816
    v_mfma_f32_16x16x32_bf16 v[32:35], v[112:115], v[168:171], v[32:35]
    ds_read_b64_tr_b16 v[98:99], v14 offset:35328
    ds_read_b128 v[180:183], v10 offset:32768
    v_mfma_f32_16x16x32_bf16 v[36:39], v[112:115], v[172:175], v[36:39]
    ds_read_b64_tr_b16 v[100:101], v15 offset:34816
    ds_read_b64_tr_b16 v[102:103], v15 offset:35328
    buffer_load_dwordx4 v20, s[48:51], s78 offen offset:3072  lds
    v_mfma_f32_16x16x32_bf16 v[40:43], v[116:119], v[168:171], v[40:43]
    ds_read_b64_tr_b16 v[104:105], v14 offset:35840
    ds_read_b64_tr_b16 v[106:107], v14 offset:36352
    v_mfma_f32_16x16x32_bf16 v[44:47], v[116:119], v[172:175], v[44:47]
    ds_read_b64_tr_b16 v[108:109], v15 offset:35840
    ds_read_b64_tr_b16 v[110:111], v15 offset:36352
    v_mfma_f32_16x16x32_bf16 v[48:51], v[120:123], v[168:171], v[48:51]
    s_mov_b32 m0, 133120
    s_cmp_eq_u32 s3, 1
    s_cselect_b32 exec_lo, -1, 0
    s_cselect_b32 exec_hi, 0, 0
    buffer_load_dword v82, s[44:47], s34 offen offset:0 lds
    s_mov_b64 exec, -1
    v_mfma_f32_16x16x32_bf16 v[52:55], v[120:123], v[172:175], v[52:55]
    v_mfma_f32_16x16x32_bf16 v[56:59], v[124:127], v[168:171], v[56:59]
    v_mfma_f32_16x16x32_bf16 v[60:63], v[124:127], v[172:175], v[60:63]
    s_lshl4_add_u32 s34, s4, s5
    s_mul_i32 s35, s34, 57344
    s_mov_b32 m0, 133120
    s_cmp_eq_u32 s3, 3
    s_cselect_b32 exec_lo, -1, 0
    s_cselect_b32 exec_hi, 0xffffff, 0
    buffer_load_dword v83, s[52:55], s35 offen offset:0 lds
    s_mov_b64 exec, -1
    s_waitcnt lgkmcnt(0)
    ds_read_b128 v[184:187], v9 offset:32768
    ds_read_b64_tr_b16 v[112:113], v14 offset:51200
    v_mfma_f32_16x16x32_bf16 v[32:35], v[96:99], v[176:179], v[32:35]
    ds_read_b64_tr_b16 v[114:115], v14 offset:51712
    ds_read_b128 v[188:191], v11 offset:32768
    v_mfma_f32_16x16x32_bf16 v[36:39], v[96:99], v[180:183], v[36:39]
    ds_read_b64_tr_b16 v[116:117], v15 offset:51200
    ds_read_b64_tr_b16 v[118:119], v15 offset:51712
    v_mfma_f32_16x16x32_bf16 v[40:43], v[100:103], v[176:179], v[40:43]
    ds_read_b64_tr_b16 v[120:121], v14 offset:52224
    ds_read_b64_tr_b16 v[122:123], v14 offset:52736
    s_lshl_b32 s35, s34, 14
    s_mov_b32 m0, 133120
    s_cmp_eq_u32 s3, 4
    s_cselect_b32 exec_lo, 0xffff, 0
    s_cselect_b32 exec_hi, 0, 0
    buffer_load_dword v83, s[56:59], s35 offen offset:0 lds
    s_mov_b64 exec, -1
    v_mfma_f32_16x16x32_bf16 v[44:47], v[100:103], v[180:183], v[44:47]
    ds_read_b64_tr_b16 v[124:125], v15 offset:52224
    ds_read_b64_tr_b16 v[126:127], v15 offset:52736
    v_mfma_f32_16x16x32_bf16 v[48:51], v[104:107], v[176:179], v[48:51]
    v_mfma_f32_16x16x32_bf16 v[52:55], v[104:107], v[180:183], v[52:55]
    s_mov_b32 m0, 133120
    s_cmp_eq_u32 s3, 5
    s_cselect_b32 exec_lo, 1, 0
    s_cselect_b32 exec_hi, 0, 0
    buffer_load_dword v27, s[60:63], s85 offen offset:0 lds
    s_mov_b64 exec, -1
    v_mfma_f32_16x16x32_bf16 v[56:59], v[108:111], v[176:179], v[56:59]
    v_mfma_f32_16x16x32_bf16 v[60:63], v[108:111], v[180:183], v[60:63]
    s_waitcnt vmcnt(8) lgkmcnt(0)
    s_barrier
    ds_read_b128 v[192:195], v4 offset:0
    ds_read_b64_tr_b16 v[96:97], v12 offset:2048
    v_mfma_f32_16x16x32_bf16 v[32:35], v[112:115], v[184:187], v[32:35]
    ds_read_b64_tr_b16 v[98:99], v12 offset:2560
    ds_read_b128 v[196:199], v6 offset:0
    s_add_u32 m0, s68, 65536
    s_add_u32 s69, s69, 128
    s_and_b32 s69, s69, 0x3ff
    buffer_load_dwordx4 v17, s[40:43], s69 offen offset:0  lds
    v_mfma_f32_16x16x32_bf16 v[36:39], v[112:115], v[188:191], v[36:39]
    ds_read_b64_tr_b16 v[100:101], v13 offset:2048
    ds_read_b64_tr_b16 v[102:103], v13 offset:2560
    v_mfma_f32_16x16x32_bf16 v[40:43], v[116:119], v[184:187], v[40:43]
    ds_read_b64_tr_b16 v[104:105], v12 offset:3072
    ds_read_b64_tr_b16 v[106:107], v12 offset:3584
    v_mfma_f32_16x16x32_bf16 v[44:47], v[116:119], v[188:191], v[44:47]
    ds_read_b64_tr_b16 v[108:109], v13 offset:3072
    ds_read_b64_tr_b16 v[110:111], v13 offset:3584
    buffer_load_dwordx4 v18, s[40:43], s69 offen offset:1024  lds
    v_mfma_f32_16x16x32_bf16 v[48:51], v[120:123], v[184:187], v[48:51]
    v_mfma_f32_16x16x32_bf16 v[52:55], v[120:123], v[188:191], v[52:55]
    v_mfma_f32_16x16x32_bf16 v[56:59], v[124:127], v[184:187], v[56:59]
    s_mul_i32 s78, s69, 1792
    buffer_load_dwordx4 v19, s[48:51], s78 offen offset:2048  lds
    v_mfma_f32_16x16x32_bf16 v[60:63], v[124:127], v[188:191], v[60:63]
    s_waitcnt lgkmcnt(0)
    ds_read_b128 v[200:203], v5 offset:0
    ds_read_b64_tr_b16 v[112:113], v12 offset:18432
    v_mfma_f32_16x16x32_bf16 v[32:35], v[96:99], v[192:195], v[32:35]
    ds_read_b64_tr_b16 v[114:115], v12 offset:18944
    ds_read_b128 v[204:207], v7 offset:0
    v_mfma_f32_16x16x32_bf16 v[36:39], v[96:99], v[196:199], v[36:39]
    ds_read_b64_tr_b16 v[116:117], v13 offset:18432
    ds_read_b64_tr_b16 v[118:119], v13 offset:18944
    buffer_load_dwordx4 v20, s[48:51], s78 offen offset:3072  lds
    v_mfma_f32_16x16x32_bf16 v[40:43], v[100:103], v[192:195], v[40:43]
    ds_read_b64_tr_b16 v[120:121], v12 offset:19456
    ds_read_b64_tr_b16 v[122:123], v12 offset:19968
    v_mfma_f32_16x16x32_bf16 v[44:47], v[100:103], v[196:199], v[44:47]
    ds_read_b64_tr_b16 v[124:125], v13 offset:19456
    ds_read_b64_tr_b16 v[126:127], v13 offset:19968
    v_mfma_f32_16x16x32_bf16 v[48:51], v[104:107], v[192:195], v[48:51]
    s_add_u32 m0, s68, 98304
    s_add_u32 s69, s69, 128
    s_and_b32 s69, s69, 0x3ff
    buffer_load_dwordx4 v17, s[40:43], s69 offen offset:0  lds
    v_mfma_f32_16x16x32_bf16 v[52:55], v[104:107], v[196:199], v[52:55]
    v_mfma_f32_16x16x32_bf16 v[56:59], v[108:111], v[192:195], v[56:59]
    v_mfma_f32_16x16x32_bf16 v[60:63], v[108:111], v[196:199], v[60:63]
    buffer_load_dwordx4 v18, s[40:43], s69 offen offset:1024  lds
    s_waitcnt vmcnt(10) lgkmcnt(0)
    s_barrier
    ds_read_b128 v[208:211], v4 offset:32768
    ds_read_b64_tr_b16 v[96:97], v12 offset:34816
    v_mfma_f32_16x16x32_bf16 v[32:35], v[112:115], v[200:203], v[32:35]
    ds_read_b64_tr_b16 v[98:99], v12 offset:35328
    ds_read_b128 v[212:215], v6 offset:32768
    v_mfma_f32_16x16x32_bf16 v[36:39], v[112:115], v[204:207], v[36:39]
    ds_read_b64_tr_b16 v[100:101], v13 offset:34816
    ds_read_b64_tr_b16 v[102:103], v13 offset:35328
    v_mfma_f32_16x16x32_bf16 v[40:43], v[116:119], v[200:203], v[40:43]
    ds_read_b64_tr_b16 v[104:105], v12 offset:35840
    ds_read_b64_tr_b16 v[106:107], v12 offset:36352
    s_mul_i32 s78, s69, 1792
    buffer_load_dwordx4 v19, s[48:51], s78 offen offset:2048  lds
    v_mfma_f32_16x16x32_bf16 v[44:47], v[116:119], v[204:207], v[44:47]
    ds_read_b64_tr_b16 v[108:109], v13 offset:35840
    ds_read_b64_tr_b16 v[110:111], v13 offset:36352
    v_mfma_f32_16x16x32_bf16 v[48:51], v[120:123], v[200:203], v[48:51]
    v_mfma_f32_16x16x32_bf16 v[52:55], v[120:123], v[204:207], v[52:55]
    buffer_load_dwordx4 v20, s[48:51], s78 offen offset:3072  lds
    v_mfma_f32_16x16x32_bf16 v[56:59], v[124:127], v[200:203], v[56:59]
    v_mfma_f32_16x16x32_bf16 v[60:63], v[124:127], v[204:207], v[60:63]
    s_waitcnt lgkmcnt(0)
    ds_read_b128 v[216:219], v5 offset:32768
    ds_read_b64_tr_b16 v[112:113], v12 offset:51200
    v_mfma_f32_16x16x32_bf16 v[32:35], v[96:99], v[208:211], v[32:35]
    ds_read_b64_tr_b16 v[114:115], v12 offset:51712
    ds_read_b128 v[220:223], v7 offset:32768
    global_load_dword v28, v30, s[36:37] sc1
    v_mfma_f32_16x16x32_bf16 v[36:39], v[96:99], v[212:215], v[36:39]
    ds_read_b64_tr_b16 v[116:117], v13 offset:51200
    ds_read_b64_tr_b16 v[118:119], v13 offset:51712
    v_mfma_f32_16x16x32_bf16 v[40:43], v[100:103], v[208:211], v[40:43]
    ds_read_b64_tr_b16 v[120:121], v12 offset:52224
    ds_read_b64_tr_b16 v[122:123], v12 offset:52736
    v_mfma_f32_16x16x32_bf16 v[44:47], v[100:103], v[212:215], v[44:47]
    ds_read_b64_tr_b16 v[124:125], v13 offset:52224
    ds_read_b64_tr_b16 v[126:127], v13 offset:52736
    s_add_u32 m0, s68, 0
    s_add_u32 s69, s69, 128
    s_and_b32 s69, s69, 0x3ff
    s_mul_i32 s78, s69, 1536
    s_add_u32 s78, s78, 4096
    buffer_load_dwordx4 v21, s[44:47], s78 offen offset:0  lds
    v_mfma_f32_16x16x32_bf16 v[48:51], v[104:107], v[208:211], v[48:51]
    v_mfma_f32_16x16x32_bf16 v[52:55], v[104:107], v[212:215], v[52:55]
    v_mfma_f32_16x16x32_bf16 v[56:59], v[108:111], v[208:211], v[56:59]
    s_add_u32 s69, s69, 128
    s_and_b32 s69, s69, 0x3ff
    s_mul_i32 s78, s69, 1536
    s_add_u32 s78, s78, 3072
    buffer_load_dwordx4 v21, s[44:47], s78 offen offset:1024  lds
    v_mfma_f32_16x16x32_bf16 v[60:63], v[108:111], v[212:215], v[60:63]
    s_waitcnt vmcnt(7) lgkmcnt(0)
    s_barrier
    ds_read_b128 v[224:227], v8 offset:0
    ds_read_b64_tr_b16 v[96:97], v14 offset:2048
    v_mfma_f32_16x16x32_bf16 v[32:35], v[112:115], v[216:219], v[32:35]
    ds_read_b64_tr_b16 v[98:99], v14 offset:2560
    ds_read_b128 v[228:231], v10 offset:0
    v_mfma_f32_16x16x32_bf16 v[36:39], v[112:115], v[220:223], v[36:39]
    ds_read_b64_tr_b16 v[100:101], v15 offset:2048
    ds_read_b64_tr_b16 v[102:103], v15 offset:2560
    s_add_u32 s69, s69, 128
    s_and_b32 s69, s69, 0x3ff
    s_mul_i32 s78, s69, 1536
    s_add_u32 s78, s78, 2048
    buffer_load_dwordx4 v21, s[44:47], s78 offen offset:2048  lds
    v_mfma_f32_16x16x32_bf16 v[40:43], v[116:119], v[216:219], v[40:43]
    ds_read_b64_tr_b16 v[104:105], v14 offset:3072
    ds_read_b64_tr_b16 v[106:107], v14 offset:3584
    v_mfma_f32_16x16x32_bf16 v[44:47], v[116:119], v[220:223], v[44:47]
    ds_read_b64_tr_b16 v[108:109], v15 offset:3072
    ds_read_b64_tr_b16 v[110:111], v15 offset:3584
    v_mfma_f32_16x16x32_bf16 v[48:51], v[120:123], v[216:219], v[48:51]
    s_add_u32 s69, s69, 128
    s_and_b32 s69, s69, 0x3ff
    s_mul_i32 s78, s69, 1536
    s_add_u32 s78, s78, 1024
    buffer_load_dwordx4 v21, s[44:47], s78 offen offset:3072  lds
    v_mfma_f32_16x16x32_bf16 v[52:55], v[120:123], v[220:223], v[52:55]
    v_mfma_f32_16x16x32_bf16 v[56:59], v[124:127], v[216:219], v[56:59]
    v_mfma_f32_16x16x32_bf16 v[60:63], v[124:127], v[220:223], v[60:63]
    s_add_u32 m0, s68, 32768
    s_add_u32 s69, s69, 128
    s_and_b32 s69, s69, 0x3ff
    s_mul_i32 s78, s69, 1536
    s_add_u32 s78, s78, 4096
    buffer_load_dwordx4 v21, s[44:47], s78 offen offset:0  lds
    s_waitcnt lgkmcnt(0)
    ds_read_b128 v[232:235], v9 offset:0
    ds_read_b64_tr_b16 v[112:113], v14 offset:18432
    v_mfma_f32_16x16x32_bf16 v[32:35], v[96:99], v[224:227], v[32:35]
    ds_read_b64_tr_b16 v[114:115], v14 offset:18944
    ds_read_b128 v[236:239], v11 offset:0
    v_mfma_f32_16x16x32_bf16 v[36:39], v[96:99], v[228:231], v[36:39]
    ds_read_b64_tr_b16 v[116:117], v15 offset:18432
    ds_read_b64_tr_b16 v[118:119], v15 offset:18944
    v_mfma_f32_16x16x32_bf16 v[40:43], v[100:103], v[224:227], v[40:43]
    ds_read_b64_tr_b16 v[120:121], v14 offset:19456
    ds_read_b64_tr_b16 v[122:123], v14 offset:19968
    s_add_u32 s69, s69, 128
    s_and_b32 s69, s69, 0x3ff
    s_mul_i32 s78, s69, 1536
    s_add_u32 s78, s78, 3072
    buffer_load_dwordx4 v21, s[44:47], s78 offen offset:1024  lds
    v_mfma_f32_16x16x32_bf16 v[44:47], v[100:103], v[228:231], v[44:47]
    ds_read_b64_tr_b16 v[124:125], v15 offset:19456
    ds_read_b64_tr_b16 v[126:127], v15 offset:19968
    v_mfma_f32_16x16x32_bf16 v[48:51], v[104:107], v[224:227], v[48:51]
    v_mfma_f32_16x16x32_bf16 v[52:55], v[104:107], v[228:231], v[52:55]
    s_add_u32 s69, s69, 128
    s_and_b32 s69, s69, 0x3ff
    s_mul_i32 s78, s69, 1536
    s_add_u32 s78, s78, 2048
    buffer_load_dwordx4 v21, s[44:47], s78 offen offset:2048  lds
    v_mfma_f32_16x16x32_bf16 v[56:59], v[108:111], v[224:227], v[56:59]
    v_mfma_f32_16x16x32_bf16 v[60:63], v[108:111], v[228:231], v[60:63]
    s_waitcnt vmcnt(8) lgkmcnt(0)
    s_barrier
    ds_read_b128 v[240:243], v8 offset:32768
    ds_read_b64_tr_b16 v[96:97], v14 offset:34816
    v_mfma_f32_16x16x32_bf16 v[32:35], v[112:115], v[232:235], v[32:35]
    ds_read_b64_tr_b16 v[98:99], v14 offset:35328
    ds_read_b128 v[244:247], v10 offset:32768
    s_add_u32 s69, s69, 128
    s_and_b32 s69, s69, 0x3ff
    s_mul_i32 s78, s69, 1536
    s_add_u32 s78, s78, 1024
    buffer_load_dwordx4 v21, s[44:47], s78 offen offset:3072  lds
    v_mfma_f32_16x16x32_bf16 v[36:39], v[112:115], v[236:239], v[36:39]
    ds_read_b64_tr_b16 v[100:101], v15 offset:34816
    ds_read_b64_tr_b16 v[102:103], v15 offset:35328
    v_mfma_f32_16x16x32_bf16 v[40:43], v[116:119], v[232:235], v[40:43]
    ds_read_b64_tr_b16 v[104:105], v14 offset:35840
    ds_read_b64_tr_b16 v[106:107], v14 offset:36352
    v_mfma_f32_16x16x32_bf16 v[44:47], v[116:119], v[236:239], v[44:47]
    ds_read_b64_tr_b16 v[108:109], v15 offset:35840
    ds_read_b64_tr_b16 v[110:111], v15 offset:36352
    s_add_u32 m0, s68, 65536
    s_add_u32 s78, s74, 135168
    buffer_load_dwordx4 v23, s[52:55], s78 offen offset:0  lds
    v_mfma_f32_16x16x32_bf16 v[48:51], v[120:123], v[232:235], v[48:51]
    v_mfma_f32_16x16x32_bf16 v[52:55], v[120:123], v[236:239], v[52:55]
    v_mfma_f32_16x16x32_bf16 v[56:59], v[124:127], v[232:235], v[56:59]
    s_add_u32 s78, s74, 142336
    buffer_load_dwordx4 v23, s[52:55], s78 offen offset:1024  lds
    v_mfma_f32_16x16x32_bf16 v[60:63], v[124:127], v[236:239], v[60:63]
    s_waitcnt lgkmcnt(0)
    ds_read_b128 v[248:251], v9 offset:32768
    ds_read_b64_tr_b16 v[112:113], v14 offset:51200
    v_mfma_f32_16x16x32_bf16 v[32:35], v[96:99], v[240:243], v[32:35]
    ds_read_b64_tr_b16 v[114:115], v14 offset:51712
    ds_read_b128 v[252:255], v11 offset:32768
    v_mfma_f32_16x16x32_bf16 v[36:39], v[96:99], v[244:247], v[36:39]
    ds_read_b64_tr_b16 v[116:117], v15 offset:51200
    ds_read_b64_tr_b16 v[118:119], v15 offset:51712
    s_add_u32 s78, s74, 165888
    buffer_load_dwordx4 v23, s[52:55], s78 offen offset:2048  lds
    v_mfma_f32_16x16x32_bf16 v[40:43], v[100:103], v[240:243], v[40:43]
    ds_read_b64_tr_b16 v[120:121], v14 offset:52224
    ds_read_b64_tr_b16 v[122:123], v14 offset:52736
    v_mfma_f32_16x16x32_bf16 v[44:47], v[100:103], v[244:247], v[44:47]
    ds_read_b64_tr_b16 v[124:125], v15 offset:52224
    ds_read_b64_tr_b16 v[126:127], v15 offset:52736
    v_mfma_f32_16x16x32_bf16 v[48:51], v[104:107], v[240:243], v[48:51]
    s_add_u32 s78, s74, 173056
    buffer_load_dwordx4 v23, s[52:55], s78 offen offset:3072  lds
    v_mfma_f32_16x16x32_bf16 v[52:55], v[104:107], v[244:247], v[52:55]
    v_mfma_f32_16x16x32_bf16 v[56:59], v[108:111], v[240:243], v[56:59]
    v_mfma_f32_16x16x32_bf16 v[60:63], v[108:111], v[244:247], v[60:63]
    s_waitcnt vmcnt(8) lgkmcnt(0)
    s_barrier
    v_readfirstlane_b32 s12, v28
    s_nop 0
    s_cmp_lg_u32 s12, 0
    s_cbranch_scc1 L_epok12
    s_mov_b32 s86, 0
L_eplp13:
    global_load_dword v28, v30, s[36:37] sc1
    s_waitcnt vmcnt(0)
    v_readfirstlane_b32 s12, v28
    s_add_u32 s86, s86, 1
    s_cmp_lg_u32 s12, 0
    s_cbranch_scc1 L_epok12
    s_cmp_lt_u32 s86, 0x100000
    s_cbranch_scc1 L_eplp13
L_epok12:
    v_mov_b32 v0, s12
    ds_read_b64_tr_b16 v[96:97], v12 offset:0
    ds_read_b64_tr_b16 v[98:99], v12 offset:512
    v_mfma_f32_16x16x32_bf16 v[32:35], v[112:115], v[248:251], v[32:35]
    ds_read_b64_tr_b16 v[100:101], v13 offset:0
    ds_read_b64_tr_b16 v[102:103], v13 offset:512
    v_mfma_f32_16x16x32_bf16 v[36:39], v[112:115], v[252:255], v[36:39]
    ds_read_b128 v[84:87], v16 offset:0
    v_mfma_f32_16x16x32_bf16 v[40:43], v[116:119], v[248:251], v[40:43]
    s_add_u32 m0, s68, 98304
    s_add_u32 s78, s74, 200704
    buffer_load_dwordx4 v23, s[52:55], s78 offen offset:0  lds
    v_mfma_f32_16x16x32_bf16 v[44:47], v[116:119], v[252:255], v[44:47]
    v_mfma_f32_16x16x32_bf16 v[48:51], v[120:123], v[248:251], v[48:51]
    v_mfma_f32_16x16x32_bf16 v[52:55], v[120:123], v[252:255], v[52:55]
    s_add_u32 s78, s74, 207872
    buffer_load_dwordx4 v23, s[52:55], s78 offen offset:1024  lds
    v_mfma_f32_16x16x32_bf16 v[56:59], v[124:127], v[248:251], v[56:59]
    v_mfma_f32_16x16x32_bf16 v[60:63], v[124:127], v[252:255], v[60:63]
    ds_read_b64_tr_b16 v[104:105], v12 offset:16384
    ds_read_b64_tr_b16 v[106:107], v12 offset:16896
    ds_read_b64_tr_b16 v[108:109], v13 offset:16384
    ds_read_b64_tr_b16 v[110:111], v13 offset:16896
    ds_read_b128 v[120:123], v16 offset:64
    s_waitcnt lgkmcnt(5)
    v_max_f32 v32, 0, v32
    v_max_f32 v33, 0, v33
    v_max_f32 v34, 0, v34
    v_max_f32 v35, 0, v35
    v_mul_f32 v32, v32, v32
    v_mul_f32 v33, v33, v33
    v_mul_f32 v34, v34, v34
    v_mul_f32 v35, v35, v35
    v_cvt_pk_bf16_f32 v88, v32, v33
    v_cvt_pk_bf16_f32 v89, v34, v35
    v_max_f32 v40, 0, v40
    v_max_f32 v41, 0, v41
    v_max_f32 v42, 0, v42
    v_max_f32 v43, 0, v43
    v_mul_f32 v40, v40, v40
    v_mul_f32 v41, v41, v41
    v_mul_f32 v42, v42, v42
    v_mul_f32 v43, v43, v43
    v_cvt_pk_bf16_f32 v90, v40, v41
    v_cvt_pk_bf16_f32 v91, v42, v43
    buffer_store_dwordx4 v[88:91], v2, s[60:63], s72 offen offset:0 sc1
    v_max_f32 v36, 0, v36
    v_max_f32 v37, 0, v37
    v_max_f32 v38, 0, v38
    v_max_f32 v39, 0, v39
    v_mul_f32 v36, v36, v36
    v_mul_f32 v37, v37, v37
    v_mul_f32 v38, v38, v38
    v_mul_f32 v39, v39, v39
    v_cvt_pk_bf16_f32 v92, v36, v37
    v_cvt_pk_bf16_f32 v93, v38, v39
    v_max_f32 v44, 0, v44
    v_max_f32 v45, 0, v45
    v_max_f32 v46, 0, v46
    v_max_f32 v47, 0, v47
    v_mul_f32 v44, v44, v44
    v_mul_f32 v45, v45, v45
    v_mul_f32 v46, v46, v46
    v_mul_f32 v47, v47, v47
    v_cvt_pk_bf16_f32 v94, v44, v45
    v_cvt_pk_bf16_f32 v95, v46, v47
    buffer_store_dwordx4 v[92:95], v2, s[60:63], s73 offen offset:0 sc1
    v_max_f32 v48, 0, v48
    v_max_f32 v49, 0, v49
    v_max_f32 v50, 0, v50
    v_max_f32 v51, 0, v51
    v_mul_f32 v48, v48, v48
    v_mul_f32 v49, v49, v49
    v_mul_f32 v50, v50, v50
    v_mul_f32 v51, v51, v51
    v_cvt_pk_bf16_f32 v88, v48, v49
    v_cvt_pk_bf16_f32 v89, v50, v51
    v_max_f32 v56, 0, v56
    v_max_f32 v57, 0, v57
    v_max_f32 v58, 0, v58
    v_max_f32 v59, 0, v59
    v_mul_f32 v56, v56, v56
    v_mul_f32 v57, v57, v57
    v_mul_f32 v58, v58, v58
    v_mul_f32 v59, v59, v59
    v_cvt_pk_bf16_f32 v90, v56, v57
    v_cvt_pk_bf16_f32 v91, v58, v59
    buffer_store_dwordx4 v[88:91], v2, s[60:63], s72 offen offset:2048 sc1
    v_max_f32 v52, 0, v52
    v_max_f32 v53, 0, v53
    v_max_f32 v54, 0, v54
    v_max_f32 v55, 0, v55
    v_mul_f32 v52, v52, v52
    v_mul_f32 v53, v53, v53
    v_mul_f32 v54, v54, v54
    v_mul_f32 v55, v55, v55
    v_cvt_pk_bf16_f32 v92, v52, v53
    v_cvt_pk_bf16_f32 v93, v54, v55
    v_max_f32 v60, 0, v60
    v_max_f32 v61, 0, v61
    v_max_f32 v62, 0, v62
    v_max_f32 v63, 0, v63
    v_mul_f32 v60, v60, v60
    v_mul_f32 v61, v61, v61
    v_mul_f32 v62, v62, v62
    v_mul_f32 v63, v63, v63
    v_cvt_pk_bf16_f32 v94, v60, v61
    v_cvt_pk_bf16_f32 v95, v62, v63
    buffer_store_dwordx4 v[92:95], v2, s[60:63], s73 offen offset:2048 sc1
    ds_read_b64_tr_b16 v[112:113], v12 offset:1024
    ds_read_b64_tr_b16 v[114:115], v12 offset:1536
    v_mfma_f32_16x16x32_bf16 v[64:67], v[96:99], v[128:131], v[76:79]
    ds_read_b64_tr_b16 v[116:117], v13 offset:1024
    ds_read_b64_tr_b16 v[118:119], v13 offset:1536
    v_lshrrev_b32 v29, 2, v1
    s_mul_i32 s13, s10, 8224
    s_add_u32 s78, s74, 231424
    buffer_load_dwordx4 v23, s[52:55], s78 offen offset:2048  lds
    v_mfma_f32_16x16x32_bf16 v[68:71], v[96:99], v[132:135], v[76:79]
    ds_read_b128 v[124:127], v16 offset:128
    v_lshl_add_u32 v29, v29, 7, v31
    s_lshl2_add_u32 s14, s11, s10
    v_mfma_f32_16x16x32_bf16 v[72:75], v[100:103], v[128:131], v[76:79]
    v_xor_b32 v4, s13, v29
    s_lshl_b32 s14, s14, 11
    s_add_u32 s78, s74, 238592
    buffer_load_dwordx4 v23, s[52:55], s78 offen offset:3072  lds
    v_mfma_f32_16x16x32_bf16 v[76:79], v[100:103], v[132:135], v[76:79]
    v_xor_b32 v5, 32, v4
    v_xor_b32 v6, 64, v4
    v_mfma_f32_16x16x32_bf16 v[80:83], v[84:87], v[128:131], 0
    v_xor_b32 v7, 96, v4
    s_add_u32 s14, s14, 65536
    s_waitcnt lgkmcnt(5)
    ds_read_b64_tr_b16 v[96:97], v12 offset:17408
    ds_read_b64_tr_b16 v[98:99], v12 offset:17920
    v_mfma_f32_16x16x32_bf16 v[64:67], v[104:107], v[136:139], v[64:67]
    ds_read_b64_tr_b16 v[100:101], v13 offset:17408
    ds_read_b64_tr_b16 v[102:103], v13 offset:17920
    v_add_u32 v8, 0x10000, v4
    v_add_u32 v9, 0x10000, v5
    v_mfma_f32_16x16x32_bf16 v[68:71], v[104:107], v[140:143], v[68:71]
    ds_read_b128 v[84:87], v16 offset:192
    v_add_u32 v10, 0x10000, v6
    v_add_u32 v11, 0x10000, v7
    v_mfma_f32_16x16x32_bf16 v[72:75], v[108:111], v[136:139], v[72:75]
    v_add_u32 v20, s14, v2
    v_xor_b32 v17, 2048, v20
    v_mfma_f32_16x16x32_bf16 v[76:79], v[108:111], v[140:143], v[76:79]
    v_xor_b32 v18, 4096, v20
    v_xor_b32 v19, 6144, v20
    v_mfma_f32_16x16x32_bf16 v[80:83], v[120:123], v[136:139], v[80:83]
    v_add_u32 v29, 0x1000, v2
    v_add_u32 v31, 0x2000, v2
    s_waitcnt lgkmcnt(5)
    ds_read_b64_tr_b16 v[104:105], v12 offset:2048
    ds_read_b64_tr_b16 v[106:107], v12 offset:2560
    v_mfma_f32_16x16x32_bf16 v[64:67], v[112:115], v[144:147], v[64:67]
    ds_read_b64_tr_b16 v[108:109], v13 offset:2048
    ds_read_b64_tr_b16 v[110:111], v13 offset:2560
    s_lshl1_add_u32 s13, s70, s11
    s_lshl_b32 s13, s13, 5
    v_mfma_f32_16x16x32_bf16 v[68:71], v[112:115], v[148:151], v[68:71]
    ds_read_b128 v[120:123], v16 offset:256
    s_add_u32 s13, s13, s10
    s_lshl2_add_u32 s79, s13, 0x1000
    v_mfma_f32_16x16x32_bf16 v[72:75], v[116:119], v[144:147], v[72:75]
    s_lshl_b32 s15, s13, 7
    s_lshl_b32 s35, s13, 10
    v_mfma_f32_16x16x32_bf16 v[76:79], v[116:119], v[148:151], v[76:79]
    s_add_u32 s15, s15, 0x180000
    s_add_u32 s35, s35, 0x100000
    v_mfma_f32_16x16x32_bf16 v[80:83], v[124:127], v[144:147], v[80:83]
    v_and_b32 v24, 15, v1
    v_lshlrev_b32 v25, 2, v24
    s_waitcnt lgkmcnt(5)
    ds_read_b64_tr_b16 v[112:113], v12 offset:18432
    ds_read_b64_tr_b16 v[114:115], v12 offset:18944
    v_mfma_f32_16x16x32_bf16 v[64:67], v[96:99], v[152:155], v[64:67]
    ds_read_b64_tr_b16 v[116:117], v13 offset:18432
    ds_read_b64_tr_b16 v[118:119], v13 offset:18944
    v_lshl_add_u32 v25, v3, 10, v25
    v_mfma_f32_16x16x32_bf16 v[68:71], v[96:99], v[156:159], v[68:71]
    ds_read_b128 v[124:127], v16 offset:320
    v_mfma_f32_16x16x32_bf16 v[72:75], v[100:103], v[152:155], v[72:75]
    v_mfma_f32_16x16x32_bf16 v[76:79], v[100:103], v[156:159], v[76:79]
    v_mfma_f32_16x16x32_bf16 v[80:83], v[84:87], v[152:155], v[80:83]
    s_waitcnt lgkmcnt(5)
    ds_read_b64_tr_b16 v[96:97], v12 offset:3072
    ds_read_b64_tr_b16 v[98:99], v12 offset:3584
    v_mfma_f32_16x16x32_bf16 v[64:67], v[104:107], v[160:163], v[64:67]
    ds_read_b64_tr_b16 v[100:101], v13 offset:3072
    ds_read_b64_tr_b16 v[102:103], v13 offset:3584
    v_mfma_f32_16x16x32_bf16 v[68:71], v[104:107], v[164:167], v[68:71]
    ds_read_b128 v[84:87], v16 offset:384
    v_mfma_f32_16x16x32_bf16 v[72:75], v[108:111], v[160:163], v[72:75]
    v_mfma_f32_16x16x32_bf16 v[76:79], v[108:111], v[164:167], v[76:79]
    v_mfma_f32_16x16x32_bf16 v[80:83], v[120:123], v[160:163], v[80:83]
    s_waitcnt lgkmcnt(5)
    ds_read_b64_tr_b16 v[104:105], v12 offset:19456
    ds_read_b64_tr_b16 v[106:107], v12 offset:19968
    v_mfma_f32_16x16x32_bf16 v[64:67], v[112:115], v[168:171], v[64:67]
    ds_read_b64_tr_b16 v[108:109], v13 offset:19456
    ds_read_b64_tr_b16 v[110:111], v13 offset:19968
    v_mfma_f32_16x16x32_bf16 v[68:71], v[112:115], v[172:175], v[68:71]
    ds_read_b128 v[120:123], v16 offset:448
    v_mfma_f32_16x16x32_bf16 v[72:75], v[116:119], v[168:171], v[72:75]
    v_mfma_f32_16x16x32_bf16 v[76:79], v[116:119], v[172:175], v[76:79]
    v_mfma_f32_16x16x32_bf16 v[80:83], v[124:127], v[168:171], v[80:83]
    s_waitcnt vmcnt(2)
    s_mov_b64 exec, 1
    buffer_store_dword v0, v27, s[60:63], s85 offen offset:0
    s_mov_b64 exec, -1
    s_waitcnt vmcnt(1) lgkmcnt(0)
    s_barrier
    s_lshl_b32 s86, 1, s7
    s_cmp_eq_u32 s3, 0
    s_cselect_b32 exec_lo, s86, 0
    s_mov_b32 exec_hi, 0
    buffer_store_dword v0, v27, s[60:63], s24 offen offset:0 sc1
    s_mov_b64 exec, -1
    ds_read_b64_tr_b16 v[112:113], v12 offset:32768
    ds_read_b64_tr_b16 v[114:115], v12 offset:33280
    v_mfma_f32_16x16x32_bf16 v[64:67], v[96:99], v[176:179], v[64:67]
    ds_read_b64_tr_b16 v[116:117], v13 offset:32768
    ds_read_b64_tr_b16 v[118:119], v13 offset:33280
    s_add_u32 m0, s68, 0
    s_add_u32 s78, s75, 4096
    buffer_load_dwordx4 v23, s[52:55], s78 offen offset:0  lds
    v_mfma_f32_16x16x32_bf16 v[68:71], v[96:99], v[180:183], v[68:71]
    ds_read_b128 v[124:127], v16 offset:512
    v_mfma_f32_16x16x32_bf16 v[72:75], v[100:103], v[176:179], v[72:75]
    s_add_u32 s78, s75, 11264
    buffer_load_dwordx4 v23, s[52:55], s78 offen offset:1024  lds
    v_mfma_f32_16x16x32_bf16 v[76:79], v[100:103], v[180:183], v[76:79]
    v_mfma_f32_16x16x32_bf16 v[80:83], v[84:87], v[176:179], v[80:83]
    s_add_u32 s78, s75, 34816
    buffer_load_dwordx4 v23, s[52:55], s78 offen offset:2048  lds
    ds_read_b64_tr_b16 v[96:97], v12 offset:49152
    ds_read_b64_tr_b16 v[98:99], v12 offset:49664
    v_mfma_f32_16x16x32_bf16 v[64:67], v[104:107], v[184:187], v[64:67]
    ds_read_b64_tr_b16 v[100:101], v13 offset:49152
    ds_read_b64_tr_b16 v[102:103], v13 offset:49664
    v_mfma_f32_16x16x32_bf16 v[68:71], v[104:107], v[188:191], v[68:71]
    ds_read_b128 v[84:87], v16 offset:576
    s_add_u32 s78, s75, 41984
    buffer_load_dwordx4 v23, s[52:55], s78 offen offset:3072  lds
    v_mfma_f32_16x16x32_bf16 v[72:75], v[108:111], v[184:187], v[72:75]
    v_mfma_f32_16x16x32_bf16 v[76:79], v[108:111], v[188:191], v[76:79]
    v_mfma_f32_16x16x32_bf16 v[80:83], v[120:123], v[184:187], v[80:83]
    s_waitcnt lgkmcnt(5)
    ds_read_b64_tr_b16 v[104:105], v12 offset:33792
    ds_read_b64_tr_b16 v[106:107], v12 offset:34304
    v_mfma_f32_16x16x32_bf16 v[64:67], v[112:115], v[192:195], v[64:67]
    ds_read_b64_tr_b16 v[108:109], v13 offset:33792
    ds_read_b64_tr_b16 v[110:111], v13 offset:34304
    v_mfma_f32_16x16x32_bf16 v[68:71], v[112:115], v[196:199], v[68:71]
    ds_read_b128 v[120:123], v16 offset:640
    v_mfma_f32_16x16x32_bf16 v[72:75], v[116:119], v[192:195], v[72:75]
    v_mfma_f32_16x16x32_bf16 v[76:79], v[116:119], v[196:199], v[76:79]
    v_mfma_f32_16x16x32_bf16 v[80:83], v[124:127], v[192:195], v[80:83]
    s_waitcnt lgkmcnt(5)
    ds_read_b64_tr_b16 v[112:113], v12 offset:50176
    ds_read_b64_tr_b16 v[114:115], v12 offset:50688
    v_mfma_f32_16x16x32_bf16 v[64:67], v[96:99], v[200:203], v[64:67]
    ds_read_b64_tr_b16 v[116:117], v13 offset:50176
    ds_read_b64_tr_b16 v[118:119], v13 offset:50688
    v_mfma_f32_16x16x32_bf16 v[68:71], v[96:99], v[204:207], v[68:71]
    ds_read_b128 v[124:127], v16 offset:704
    v_mfma_f32_16x16x32_bf16 v[72:75], v[100:103], v[200:203], v[72:75]
    v_mfma_f32_16x16x32_bf16 v[76:79], v[100:103], v[204:207], v[76:79]
    v_mfma_f32_16x16x32_bf16 v[80:83], v[84:87], v[200:203], v[80:83]
    s_waitcnt lgkmcnt(5)
    ds_read_b64_tr_b16 v[96:97], v12 offset:34816
    ds_read_b64_tr_b16 v[98:99], v12 offset:35328
    v_mfma_f32_16x16x32_bf16 v[64:67], v[104:107], v[208:211], v[64:67]
    ds_read_b64_tr_b16 v[100:101], v13 offset:34816
    ds_read_b64_tr_b16 v[102:103], v13 offset:35328
    buffer_load_dword v28, v27, s[60:63], s84 offen sc1
    v_mfma_f32_16x16x32_bf16 v[68:71], v[104:107], v[212:215], v[68:71]
    ds_read_b128 v[84:87], v16 offset:768
    v_mfma_f32_16x16x32_bf16 v[72:75], v[108:111], v[208:211], v[72:75]
    v_mfma_f32_16x16x32_bf16 v[76:79], v[108:111], v[212:215], v[76:79]
    v_mfma_f32_16x16x32_bf16 v[80:83], v[120:123], v[208:211], v[80:83]
    s_waitcnt lgkmcnt(5)
    ds_read_b64_tr_b16 v[104:105], v12 offset:51200
    ds_read_b64_tr_b16 v[106:107], v12 offset:51712
    v_mfma_f32_16x16x32_bf16 v[64:67], v[112:115], v[216:219], v[64:67]
    ds_read_b64_tr_b16 v[108:109], v13 offset:51200
    ds_read_b64_tr_b16 v[110:111], v13 offset:51712
    v_mfma_f32_16x16x32_bf16 v[68:71], v[112:115], v[220:223], v[68:71]
    ds_read_b128 v[120:123], v16 offset:832
    v_mfma_f32_16x16x32_bf16 v[72:75], v[116:119], v[216:219], v[72:75]
    v_mfma_f32_16x16x32_bf16 v[76:79], v[116:119], v[220:223], v[76:79]
    v_mfma_f32_16x16x32_bf16 v[80:83], v[124:127], v[216:219], v[80:83]
    s_waitcnt lgkmcnt(5)
    s_waitcnt vmcnt(0)
    v_cmp_ne_u32 vcc, s12, v28
    s_nop 0
    s_and_b64 vcc, vcc, s[16:17]
    s_cbranch_scc0 L_ok14
    s_mov_b32 s86, 0
L_sp15:
    s_sleep 1
    buffer_load_dword v28, v27, s[60:63], s84 offen sc1
    s_waitcnt vmcnt(0)
    v_cmp_ne_u32 vcc, s12, v28
    s_nop 0
    s_and_b64 vcc, vcc, s[16:17]
    s_cbranch_scc0 L_ok14
    s_add_u32 s86, s86, 1
    s_and_b32 vcc_lo, s86, 7
    s_cbranch_scc1 L_sp15
    buffer_load_dword v28, v27, s[60:63], s24 offen sc1
    s_waitcnt vmcnt(0)
    v_cmp_ne_u32 vcc, s12, v28
    v_mov_b32 v28, 0
    s_and_b32 vcc_lo, vcc_lo, 0xf
    s_cbranch_scc0 L_ok14
    s_cmp_lt_u32 s86, 0x100000
    s_cbranch_scc1 L_sp15
L_ok14:
    ds_read_b64_tr_b16 v[112:113], v12 offset:35840
    ds_read_b64_tr_b16 v[114:115], v12 offset:36352
    v_mfma_f32_16x16x32_bf16 v[64:67], v[96:99], v[224:227], v[64:67]
    ds_read_b64_tr_b16 v[116:117], v13 offset:35840
    ds_read_b64_tr_b16 v[118:119], v13 offset:36352
    buffer_load_dwordx4 v[132:135], v2, s[60:63], s80 offen offset:0 sc1
    v_mfma_f32_16x16x32_bf16 v[68:71], v[96:99], v[228:231], v[68:71]
    ds_read_b128 v[124:127], v16 offset:896
    v_mfma_f32_16x16x32_bf16 v[72:75], v[100:103], v[224:227], v[72:75]
    ds_read_b64_tr_b16 v[128:129], v8 offset:2048
    ds_read_b64_tr_b16 v[130:131], v8 offset:6144
    buffer_load_dwordx4 v[140:143], v2, s[60:63], s81 offen offset:0 sc1
    v_mfma_f32_16x16x32_bf16 v[76:79], v[100:103], v[228:231], v[76:79]
    ds_read_b64_tr_b16 v[136:137], v9 offset:2048
    ds_read_b64_tr_b16 v[138:139], v9 offset:6144
    v_mfma_f32_16x16x32_bf16 v[80:83], v[84:87], v[224:227], v[80:83]
    ds_read_b64_tr_b16 v[144:145], v10 offset:2048
    ds_read_b64_tr_b16 v[146:147], v10 offset:6144
    buffer_load_dwordx4 v[148:151], v2, s[60:63], s80 offen offset:1024 sc1
    s_waitcnt lgkmcnt(11)
    ds_read_b64_tr_b16 v[96:97], v12 offset:52224
    ds_read_b64_tr_b16 v[98:99], v12 offset:52736
    v_mfma_f32_16x16x32_bf16 v[64:67], v[104:107], v[232:235], v[64:67]
    ds_read_b64_tr_b16 v[100:101], v13 offset:52224
    ds_read_b64_tr_b16 v[102:103], v13 offset:52736
    v_mfma_f32_16x16x32_bf16 v[68:71], v[104:107], v[236:239], v[68:71]
    ds_read_b128 v[84:87], v16 offset:960
    buffer_load_dwordx4 v[156:159], v2, s[60:63], s81 offen offset:1024 sc1
    v_mfma_f32_16x16x32_bf16 v[72:75], v[108:111], v[232:235], v[72:75]
    ds_read_b64_tr_b16 v[152:153], v11 offset:2048
    ds_read_b64_tr_b16 v[154:155], v11 offset:6144
    v_mfma_f32_16x16x32_bf16 v[76:79], v[108:111], v[236:239], v[76:79]
    ds_read_b64_tr_b16 v[160:161], v8 offset:32768
    ds_read_b64_tr_b16 v[162:163], v8 offset:36864
    buffer_load_dwordx4 v[164:167], v2, s[60:63], s80 offen offset:2048 sc1
    v_mfma_f32_16x16x32_bf16 v[80:83], v[120:123], v[232:235], v[80:83]
    ds_read_b64_tr_b16 v[168:169], v9 offset:32768
    ds_read_b64_tr_b16 v[170:171], v9 offset:36864
    s_waitcnt lgkmcnt(14)
    v_mfma_f32_16x16x32_bf16 v[64:67], v[112:115], v[240:243], v[64:67]
    ds_read_b64_tr_b16 v[176:177], v10 offset:32768
    ds_read_b64_tr_b16 v[178:179], v10 offset:36864
    buffer_load_dwordx4 v[172:175], v2, s[60:63], s81 offen offset:2048 sc1
    v_mfma_f32_16x16x32_bf16 v[68:71], v[112:115], v[244:247], v[68:71]
    ds_read_b64_tr_b16 v[184:185], v11 offset:32768
    ds_read_b64_tr_b16 v[186:187], v11 offset:36864
    v_mfma_f32_16x16x32_bf16 v[72:75], v[116:119], v[240:243], v[72:75]
    ds_read_b64_tr_b16 v[192:193], v8 offset:34816
    ds_read_b64_tr_b16 v[194:195], v8 offset:38912
    buffer_load_dwordx4 v[180:183], v2, s[60:63], s80 offen offset:3072 sc1
    v_mfma_f32_16x16x32_bf16 v[76:79], v[116:119], v[244:247], v[76:79]
    ds_read_b64_tr_b16 v[200:201], v9 offset:34816
    ds_read_b64_tr_b16 v[202:203], v9 offset:38912
    v_mfma_f32_16x16x32_bf16 v[80:83], v[124:127], v[240:243], v[80:83]
    ds_read_b64_tr_b16 v[208:209], v10 offset:34816
    ds_read_b64_tr_b16 v[210:211], v10 offset:38912
    buffer_load_dwordx4 v[188:191], v2, s[60:63], s81 offen offset:3072 sc1
    s_waitcnt lgkmcnt(14)
    v_mfma_f32_16x16x32_bf16 v[64:67], v[96:99], v[248:251], v[64:67]
    ds_read_b64_tr_b16 v[216:217], v11 offset:34816
    ds_read_b64_tr_b16 v[218:219], v11 offset:38912
    v_mfma_f32_16x16x32_bf16 v[68:71], v[96:99], v[252:255], v[68:71]
    s_mov_b64 exec, 0xff
    buffer_load_dword v22, v2, s[60:63], s79 offen sc1
    s_mov_b64 exec, -1
    v_mfma_f32_16x16x32_bf16 v[72:75], v[100:103], v[248:251], v[72:75]
    v_mfma_f32_16x16x32_bf16 v[76:79], v[100:103], v[252:255], v[76:79]
    buffer_load_dwordx4 v[196:199], v2, s[60:63], s82 offen offset:0 sc1
    v_mfma_f32_16x16x32_bf16 v[80:83], v[84:87], v[248:251], v[80:83]
    ds_read_b64_tr_b16 v[228:229], v8 offset:0
    ds_read_b64_tr_b16 v[230:231], v8 offset:4096
    ds_read_b64_tr_b16 v[236:237], v9 offset:0
    ds_read_b64_tr_b16 v[238:239], v9 offset:4096
    ds_read_b64_tr_b16 v[244:245], v10 offset:0
    ds_read_b64_tr_b16 v[246:247], v10 offset:4096
    ds_read_b64_tr_b16 v[252:253], v11 offset:0
    ds_read_b64_tr_b16 v[254:255], v11 offset:4096
    s_waitcnt lgkmcnt(0)
    s_barrier
    s_waitcnt vmcnt(1)
    v_cmp_ne_u32 vcc, s12, v22
    s_nop 0
    s_and_b32 vcc_lo, vcc_lo, 0xff
    s_cbranch_scc0 L_ok16
    s_mov_b32 s86, 0
L_sp17:
    s_sleep 4
    s_mov_b64 exec, 0xff
    buffer_load_dword v22, v2, s[60:63], s79 offen sc1
    s_mov_b64 exec, -1
    s_waitcnt vmcnt(0)
    v_cmp_ne_u32 vcc, s12, v22
    s_nop 0
    s_and_b32 vcc_lo, vcc_lo, 0xff
    s_cbranch_scc0 L_ok16
    s_add_u32 s86, s86, 1
    s_cmp_lt_u32 s86, 0x100000
    s_cbranch_scc1 L_sp17
L_ok16:
    buffer_load_dword v88, v25, s[60:63], s15 offen offset:0 sc1
    buffer_load_dword v89, v25, s[60:63], s15 offen offset:512 sc1
    buffer_load_dwordx4 v[32:35], v2, s[60:63], s35 offen sc1
    buffer_load_dwordx4 v[36:39], v29, s[60:63], s35 offen sc1
    s_add_u32 s35, s35, 8192
    buffer_load_dwordx4 v[40:43], v2, s[60:63], s35 offen sc1
    buffer_load_dwordx4 v[44:47], v29, s[60:63], s35 offen sc1
    s_add_u32 s35, s35, 8192
    buffer_load_dwordx4 v[48:51], v2, s[60:63], s35 offen sc1
    buffer_load_dwordx4 v[52:55], v29, s[60:63], s35 offen sc1
    s_add_u32 s35, s35, 8192
    buffer_load_dwordx4 v[56:59], v2, s[60:63], s35 offen sc1
    buffer_load_dwordx4 v[60:63], v29, s[60:63], s35 offen sc1
    v_mfma_f32_16x16x32_bf16 v[96:99], v[228:231], v[132:135], 0
    s_lshl_b32 s13, s87, 6
    s_add_u32 s14, s13, 122880
    v_lshl_add_u32 v13, v24, 2, s14
    v_mul_f32 v24, s22, v80
    v_exp_f32_e64 v24, -v24
    s_nop 0
    v_add_f32 v24, 1.0, v24
    v_rcp_f32 v24, v24
    s_nop 0
    ds_write_b32 v13, v24
    buffer_load_dwordx4 v[204:207], v2, s[60:63], s83 offen offset:0 sc1
    v_mfma_f32_16x16x32_bf16 v[104:107], v[236:239], v[132:135], 0
    v_xor_b32 v13, 64, v13
    s_lshl1_add_u32 s14, s5, s4
    s_lshl2_add_u32 s14, s14, s7
    s_lshl_b32 s14, s14, 10
    s_lshl1_add_u32 s13, s13, s14
    s_add_u32 s34, s13, 0x40000
    v_fma_f32 v84, v64, s22, v26
    v_fma_f32 v85, v65, s22, v26
    v_mfma_f32_16x16x32_bf16 v[112:115], v[244:247], v[132:135], 0
    v_fma_f32 v86, v66, s22, v26
    v_fma_f32 v87, v67, s22, v26
    v_exp_f32_e64 v84, v84 clamp
    v_exp_f32_e64 v85, v85 clamp
    v_exp_f32_e64 v86, v86 clamp
    v_exp_f32_e64 v87, v87 clamp
    v_max_f32 v64, s23, v64
    v_max_f32 v65, s23, v65
    buffer_load_dwordx4 v[212:215], v2, s[60:63], s82 offen offset:1024 sc1
    v_mfma_f32_16x16x32_bf16 v[120:123], v[252:255], v[132:135], 0
    v_max_f32 v66, s23, v66
    v_max_f32 v67, s23, v67
    v_add_f32 v64, v64, v84
    v_add_f32 v65, v65, v85
    v_add_f32 v66, v66, v86
    v_add_f32 v67, v67, v87
    v_cvt_pk_bf16_f32 v64, v64, v65
    v_cvt_pk_bf16_f32 v65, v66, v67
    v_mfma_f32_16x16x32_bf16 v[100:103], v[228:231], v[140:143], 0
    v_fma_f32 v84, v68, s22, v26
    v_fma_f32 v85, v69, s22, v26
    v_fma_f32 v86, v70, s22, v26
    v_fma_f32 v87, v71, s22, v26
    v_exp_f32_e64 v84, v84 clamp
    v_exp_f32_e64 v85, v85 clamp
    v_exp_f32_e64 v86, v86 clamp
    v_exp_f32_e64 v87, v87 clamp
    buffer_load_dwordx4 v[220:223], v2, s[60:63], s83 offen offset:1024 sc1
    v_mfma_f32_16x16x32_bf16 v[108:111], v[236:239], v[140:143], 0
    v_max_f32 v68, s23, v68
    v_max_f32 v69, s23, v69
    v_max_f32 v70, s23, v70
    v_max_f32 v71, s23, v71
    v_add_f32 v68, v68, v84
    v_add_f32 v69, v69, v85
    v_add_f32 v70, v70, v86
    v_add_f32 v71, v71, v87
    v_mfma_f32_16x16x32_bf16 v[116:119], v[244:247], v[140:143], 0
    v_cvt_pk_bf16_f32 v66, v68, v69
    v_cvt_pk_bf16_f32 v67, v70, v71
    v_fma_f32 v84, v72, s22, v26
    v_fma_f32 v85, v73, s22, v26
    v_fma_f32 v86, v74, s22, v26
    v_fma_f32 v87, v75, s22, v26
    v_exp_f32_e64 v84, v84 clamp
    v_exp_f32_e64 v85, v85 clamp
    s_add_u32 m0, s68, 32768
    s_add_u32 s78, s76, 397312
    buffer_load_dwordx4 v23, s[52:55], s78 offen offset:0  lds
    v_mfma_f32_16x16x32_bf16 v[124:127], v[252:255], v[140:143], 0
    v_exp_f32_e64 v86, v86 clamp
    v_exp_f32_e64 v87, v87 clamp
    v_max_f32 v72, s23, v72
    v_max_f32 v73, s23, v73
    v_max_f32 v74, s23, v74
    v_max_f32 v75, s23, v75
    v_add_f32 v72, v72, v84
    v_add_f32 v73, v73, v85
    v_mfma_f32_16x16x32_bf16 v[96:99], v[128:131], v[148:151], v[96:99]
    v_add_f32 v74, v74, v86
    v_add_f32 v75, v75, v87
    v_cvt_pk_bf16_f32 v68, v72, v73
    v_cvt_pk_bf16_f32 v69, v74, v75
    v_fma_f32 v84, v76, s22, v26
    v_fma_f32 v85, v77, s22, v26
    v_fma_f32 v86, v78, s22, v26
    v_fma_f32 v87, v79, s22, v26
    s_add_u32 s78, s76, 404480
    buffer_load_dwordx4 v23, s[52:55], s78 offen offset:1024  lds
    v_mfma_f32_16x16x32_bf16 v[104:107], v[136:139], v[148:151], v[104:107]
    v_exp_f32_e64 v84, v84 clamp
    v_exp_f32_e64 v85, v85 clamp
    v_exp_f32_e64 v86, v86 clamp
    v_exp_f32_e64 v87, v87 clamp
    v_max_f32 v76, s23, v76
    v_max_f32 v77, s23, v77
    v_max_f32 v78, s23, v78
    v_max_f32 v79, s23, v79
    v_mfma_f32_16x16x32_bf16 v[112:115], v[144:147], v[148:151], v[112:115]
    v_add_f32 v76, v76, v84
    v_add_f32 v77, v77, v85
    v_add_f32 v78, v78, v86
    v_add_f32 v79, v79, v87
    v_cvt_pk_bf16_f32 v70, v76, v77
    v_cvt_pk_bf16_f32 v71, v78, v79
    v_mov_b32 v14, 1.0
    s_waitcnt vmcnt(14)
    s_nop 0
    v_mfma_f32_16x16x4_f32 v[72:75], v88, v14, 0
    s_add_u32 s78, s77, 2048
    buffer_load_dwordx4 v23, s[56:59], s78 offen offset:2048  lds
    v_mfma_f32_16x16x32_bf16 v[120:123], v[152:155], v[148:151], v[120:123]
    s_waitcnt vmcnt(14)
    v_mfma_f32_16x16x4_f32 v[72:75], v89, v14, v[72:75]
    s_lshl_b32 s13, s3, 6
    s_add_u32 s13, s13, 123904
    v_lshl_add_u32 v21, v3, 4, s13
    s_lshl_b32 s13, s11, 8
    s_add_u32 s13, s13, 123904
    v_lshl_add_u32 v22, v3, 4, s13
    s_lshl_b32 s13, s3, 10
    v_mfma_f32_16x16x32_bf16 v[100:103], v[128:131], v[156:159], v[100:103]
    s_add_u32 s13, s13, 114688
    v_add_u32 v14, s13, v2
    s_lshl_b32 s13, s11, 12
    s_add_u32 s13, s13, 114688
    v_add_u32 v15, s13, v2
    s_waitcnt vmcnt(12)
    v_add_f32 v32, v32, v36
    v_add_f32 v33, v33, v37
    v_add_f32 v34, v34, v38
    s_add_u32 s78, s77, 9216
    buffer_load_dwordx4 v23, s[56:59], s78 offen offset:3072  lds
    v_mfma_f32_16x16x32_bf16 v[108:111], v[136:139], v[156:159], v[108:111]
    v_add_f32 v35, v35, v39
    s_waitcnt vmcnt(11)
    v_add_f32 v40, v40, v44
    v_add_f32 v41, v41, v45
    v_add_f32 v42, v42, v46
    v_add_f32 v43, v43, v47
    s_waitcnt vmcnt(9)
    v_add_f32 v48, v48, v52
    v_add_f32 v49, v49, v53
    v_add_f32 v50, v50, v54
    v_mfma_f32_16x16x32_bf16 v[116:119], v[144:147], v[156:159], v[116:119]
    v_add_f32 v51, v51, v55
    s_waitcnt vmcnt(7)
    v_add_f32 v56, v56, v60
    v_add_f32 v57, v57, v61
    v_add_f32 v58, v58, v62
    v_add_f32 v59, v59, v63
    v_add_f32 v32, v32, v40
    v_add_f32 v33, v33, v41
    v_add_f32 v34, v34, v42
    s_add_u32 m0, s68, 131072
    s_add_u32 s78, s77, 36864
    buffer_load_dwordx4 v23, s[56:59], s78 offen offset:0  lds
    v_mfma_f32_16x16x32_bf16 v[124:127], v[152:155], v[156:159], v[124:127]
    v_add_f32 v35, v35, v43
    v_add_f32 v48, v48, v56
    v_add_f32 v49, v49, v57
    v_add_f32 v50, v50, v58
    v_add_f32 v51, v51, v59
    v_add_f32 v32, v32, v48
    v_add_f32 v33, v33, v49
    v_add_f32 v34, v34, v50
    v_add_f32 v35, v35, v51
    ds_write_b128 v21, v[72:75]
    ds_write_b128 v14, v[32:35]
    s_add_u32 s72, s72, 7168
    s_add_u32 s73, s73, 7168
    s_waitcnt lgkmcnt(0)
    s_barrier
    ds_read_b128 v[32:35], v22 offset:0
    ds_read_b128 v[36:39], v22 offset:64
    ds_read_b128 v[40:43], v22 offset:128
    ds_read_b128 v[44:47], v22 offset:192
    ds_read_b128 v[224:227], v15 offset:0
    ds_read_b128 v[232:235], v15 offset:1024
    ds_read_b128 v[240:243], v15 offset:2048
    ds_read_b128 v[248:251], v15 offset:3072
    ds_read_b32 v25, v13
    s_waitcnt lgkmcnt(7)
    v_add_f32 v32, v32, v36
    v_add_f32 v33, v33, v37
    v_add_f32 v34, v34, v38
    v_add_f32 v35, v35, v39
    v_cvt_pk_bf16_f32 v80, v32, v33
    v_cvt_pk_bf16_f32 v81, v34, v35
    s_waitcnt lgkmcnt(5)
    v_add_f32 v40, v40, v44
    v_add_f32 v41, v41, v45
    v_add_f32 v42, v42, v46
    v_add_f32 v43, v43, v47
    v_cvt_pk_bf16_f32 v82, v40, v41
    v_cvt_pk_bf16_f32 v83, v42, v43
    v_mfma_f32_16x16x16_bf16 v[48:51], v[80:81], v[64:65], 0
    v_mfma_f32_16x16x16_bf16 v[52:55], v[80:81], v[66:67], 0
    v_mfma_f32_16x16x16_bf16 v[56:59], v[82:83], v[68:69], 0
    v_mfma_f32_16x16x16_bf16 v[60:63], v[82:83], v[70:71], 0
    s_waitcnt lgkmcnt(3)
    v_add_f32 v224, v224, v232
    v_add_f32 v225, v225, v233
    v_add_f32 v226, v226, v234
    v_add_f32 v227, v227, v235
    v_cvt_pk_bf16_f32 v72, v224, v225
    v_cvt_pk_bf16_f32 v73, v226, v227
    s_waitcnt lgkmcnt(1)
    v_add_f32 v240, v240, v248
    v_add_f32 v241, v241, v249
    v_add_f32 v242, v242, v250
    v_add_f32 v243, v243, v251
    v_cvt_pk_bf16_f32 v74, v240, v241
    v_cvt_pk_bf16_f32 v75, v242, v243
    v_mfma_f32_16x16x16_bf16 v[224:227], v[72:73], v[64:65], 0
    v_mfma_f32_16x16x16_bf16 v[232:235], v[72:73], v[66:67], 0
    v_mfma_f32_16x16x16_bf16 v[240:243], v[74:75], v[68:69], 0
    v_mfma_f32_16x16x16_bf16 v[248:251], v[74:75], v[70:71], 0
    v_add_f32 v84, s23, v48
    v_add_f32 v85, s23, v52
    v_add_f32 v86, s23, v56
    v_add_f32 v87, s23, v60
    v_rcp_f32 v84, v84
    v_rcp_f32 v85, v85
    v_rcp_f32 v86, v86
    v_rcp_f32 v87, v87
    v_mul_f32 v84, v84, v24
    s_waitcnt lgkmcnt(0)
    v_mul_f32 v85, v85, v25
    v_mul_f32 v86, v86, v24
    v_mul_f32 v87, v87, v25
    v_mul_f32 v224, v224, v84
    v_mul_f32 v225, v225, v84
    v_mul_f32 v226, v226, v84
    v_mul_f32 v227, v227, v84
    v_cvt_pk_bf16_f32 v88, v224, v225
    v_cvt_pk_bf16_f32 v89, v226, v227
    v_mul_f32 v240, v240, v86
    v_mul_f32 v241, v241, v86
    v_mul_f32 v242, v242, v86
    v_mul_f32 v243, v243, v86
    v_cvt_pk_bf16_f32 v90, v240, v241
    v_cvt_pk_bf16_f32 v91, v242, v243
    buffer_store_dwordx4 v[88:91], v2, s[60:63], s72 offen offset:0 sc1
    v_mul_f32 v232, v232, v85
    v_mul_f32 v233, v233, v85
    v_mul_f32 v234, v234, v85
    v_mul_f32 v235, v235, v85
    v_cvt_pk_bf16_f32 v92, v232, v233
    v_cvt_pk_bf16_f32 v93, v234, v235
    v_mul_f32 v248, v248, v87
    v_mul_f32 v249, v249, v87
    v_mul_f32 v250, v250, v87
    v_mul_f32 v251, v251, v87
    v_cvt_pk_bf16_f32 v94, v248, v249
    v_cvt_pk_bf16_f32 v95, v250, v251
    buffer_store_dwordx4 v[92:95], v2, s[60:63], s73 offen offset:0 sc1
    s_mov_b32 exec_hi, 0
    buffer_store_dword v24, v27, s[60:63], s34 offen sc1
    s_mov_b32 exec_hi, -1
    v_mfma_f32_16x16x32_bf16 v[96:99], v[160:163], v[164:167], v[96:99]
    v_and_b32 v24, 15, v1
    s_add_u32 s78, s77, 44032
    buffer_load_dwordx4 v23, s[56:59], s78 offen offset:1024  lds
    v_mfma_f32_16x16x32_bf16 v[104:107], v[168:171], v[164:167], v[104:107]
    ds_read_b64_tr_b16 v[224:225], v4 offset:0
    ds_read_b64_tr_b16 v[226:227], v4 offset:4096
    s_lshl1_add_u32 s13, s4, s11
    s_lshl2_add_u32 s13, s5, s13
    v_mfma_f32_16x16x32_bf16 v[112:115], v[176:179], v[164:167], v[112:115]
    ds_read_b64_tr_b16 v[232:233], v5 offset:0
    ds_read_b64_tr_b16 v[234:235], v5 offset:4096
    s_lshl_b32 s13, s13, 5
    s_lshl_b32 s14, s4, 9
    v_mfma_f32_16x16x32_bf16 v[120:123], v[184:187], v[164:167], v[120:123]
    ds_read_b64_tr_b16 v[240:241], v6 offset:0
    ds_read_b64_tr_b16 v[242:243], v6 offset:4096
    v_lshl_add_u32 v16, v24, 2, s14
    v_xor_b32 v21, 0x200, v16
    v_mfma_f32_16x16x32_bf16 v[100:103], v[160:163], v[172:175], v[100:103]
    ds_read_b64_tr_b16 v[248:249], v7 offset:0
    ds_read_b64_tr_b16 v[250:251], v7 offset:4096
    v_add_u32 v24, s13, v24
    s_lshl2_add_u32 s13, s6, s10
    v_mfma_f32_16x16x32_bf16 v[108:111], v[168:171], v[172:175], v[108:111]
    ds_read_b64_tr_b16 v[64:65], v4 offset:2048
    ds_read_b64_tr_b16 v[66:67], v4 offset:6144
    s_lshl_b32 s13, s13, 5
    v_lshl_add_u32 v30, v3, 3, s13
    v_mfma_f32_16x16x32_bf16 v[116:119], v[176:179], v[172:175], v[116:119]
    ds_read_b64_tr_b16 v[68:69], v5 offset:2048
    ds_read_b64_tr_b16 v[70:71], v5 offset:6144
    global_load_dwordx2 v[14:15], v30, s[30:31]
    v_lshl_add_u32 v12, v24, 10, v30
    v_mfma_f32_16x16x32_bf16 v[124:127], v[184:187], v[172:175], v[124:127]
    ds_read_b64_tr_b16 v[72:73], v6 offset:2048
    ds_read_b64_tr_b16 v[74:75], v6 offset:6144
    v_mfma_f32_16x16x32_bf16 v[96:99], v[192:195], v[180:183], v[96:99]
    ds_read_b64_tr_b16 v[76:77], v7 offset:2048
    ds_read_b64_tr_b16 v[78:79], v7 offset:6144
    buffer_load_dword v28, v27, s[60:63], s84 offen sc1
    v_mfma_f32_16x16x32_bf16 v[104:107], v[200:203], v[180:183], v[104:107]
    v_mfma_f32_16x16x32_bf16 v[112:115], v[208:211], v[180:183], v[112:115]
    v_mfma_f32_16x16x32_bf16 v[120:123], v[216:219], v[180:183], v[120:123]
    v_mfma_f32_16x16x32_bf16 v[100:103], v[192:195], v[188:191], v[100:103]
    v_mfma_f32_16x16x32_bf16 v[108:111], v[200:203], v[188:191], v[108:111]
    v_mfma_f32_16x16x32_bf16 v[116:119], v[208:211], v[188:191], v[116:119]
    v_mfma_f32_16x16x32_bf16 v[124:127], v[216:219], v[188:191], v[124:127]
    s_waitcnt vmcnt(3)
    s_mov_b64 exec, 1
    buffer_store_dword v0, v27, s[60:63], s85 offen offset:96
    s_mov_b64 exec, -1
    s_waitcnt vmcnt(1)
    v_cmp_ne_u32 vcc, s12, v28
    s_nop 0
    s_and_b64 vcc, vcc, s[18:19]
    s_cbranch_scc0 L_ok18
    s_mov_b32 s86, 0
L_sp19:
    s_sleep 1
    buffer_load_dword v28, v27, s[60:63], s84 offen sc1
    s_waitcnt vmcnt(0)
    v_cmp_ne_u32 vcc, s12, v28
    s_nop 0
    s_and_b64 vcc, vcc, s[18:19]
    s_cbranch_scc0 L_ok18
    s_add_u32 s86, s86, 1
    s_and_b32 vcc_lo, s86, 7
    s_cbranch_scc1 L_sp19
    buffer_load_dword v28, v27, s[60:63], s24 offen sc1
    s_waitcnt vmcnt(0)
    v_cmp_ne_u32 vcc, s12, v28
    v_mov_b32 v28, 0
    s_and_b32 vcc_lo, vcc_lo, 0xf0
    s_cbranch_scc0 L_ok18
    s_cmp_lt_u32 s86, 0x100000
    s_cbranch_scc1 L_sp19
L_ok18:
    v_mfma_f32_16x16x32_bf16 v[32:35], v[228:231], v[196:199], 0
    buffer_load_dwordx4 v[132:135], v29, s[60:63], s80 offen offset:0 sc1
    v_mfma_f32_16x16x32_bf16 v[40:43], v[236:239], v[196:199], 0
    v_mfma_f32_16x16x32_bf16 v[48:51], v[244:247], v[196:199], 0
    buffer_load_dwordx4 v[140:143], v29, s[60:63], s81 offen offset:0 sc1
    v_mfma_f32_16x16x32_bf16 v[56:59], v[252:255], v[196:199], 0
    v_mfma_f32_16x16x32_bf16 v[36:39], v[228:231], v[204:207], 0
    buffer_load_dwordx4 v[148:151], v29, s[60:63], s80 offen offset:1024 sc1
    v_mfma_f32_16x16x32_bf16 v[44:47], v[236:239], v[204:207], 0
    v_mfma_f32_16x16x32_bf16 v[52:55], v[244:247], v[204:207], 0
    buffer_load_dwordx4 v[156:159], v29, s[60:63], s81 offen offset:1024 sc1
    v_mfma_f32_16x16x32_bf16 v[60:63], v[252:255], v[204:207], 0
    v_mfma_f32_16x16x32_bf16 v[32:35], v[128:131], v[212:215], v[32:35]
    v_mfma_f32_16x16x32_bf16 v[40:43], v[136:139], v[212:215], v[40:43]
    v_mfma_f32_16x16x32_bf16 v[48:51], v[144:147], v[212:215], v[48:51]
    v_mfma_f32_16x16x32_bf16 v[56:59], v[152:155], v[212:215], v[56:59]
    v_mfma_f32_16x16x32_bf16 v[36:39], v[128:131], v[220:223], v[36:39]
    v_mfma_f32_16x16x32_bf16 v[44:47], v[136:139], v[220:223], v[44:47]
    v_mfma_f32_16x16x32_bf16 v[52:55], v[144:147], v[220:223], v[52:55]
    v_mfma_f32_16x16x32_bf16 v[60:63], v[152:155], v[220:223], v[60:63]
    s_waitcnt lgkmcnt(0)
    s_barrier
    s_lshl_b32 s86, 1, s7
    s_cmp_eq_u32 s3, 0
    s_cselect_b32 exec_lo, s86, 0
    s_mov_b32 exec_hi, 0
    buffer_store_dword v0, v27, s[60:63], s24 offen offset:48 sc1
    s_mov_b64 exec, -1
    s_waitcnt vmcnt(4)
    v_mfma_f32_16x16x32_bf16 v[96:99], v[224:227], v[132:135], v[96:99]
    ds_read_b64_tr_b16 v[80:81], v4 offset:32768
    ds_read_b64_tr_b16 v[82:83], v4 offset:36864
    buffer_load_dword v28, v27, s[60:63], s84 offen sc1
    v_mfma_f32_16x16x32_bf16 v[104:107], v[232:235], v[132:135], v[104:107]
    ds_read_b64_tr_b16 v[84:85], v5 offset:32768
    ds_read_b64_tr_b16 v[86:87], v5 offset:36864
    v_mfma_f32_16x16x32_bf16 v[112:115], v[240:243], v[132:135], v[112:115]
    ds_read_b64_tr_b16 v[88:89], v6 offset:32768
    ds_read_b64_tr_b16 v[90:91], v6 offset:36864
    buffer_load_dwordx4 v[212:215], v2, s[60:63], s82 offen offset:2048 sc1
    v_mfma_f32_16x16x32_bf16 v[120:123], v[248:251], v[132:135], v[120:123]
    ds_read_b64_tr_b16 v[92:93], v7 offset:32768
    ds_read_b64_tr_b16 v[94:95], v7 offset:36864
    s_waitcnt vmcnt(5)
    v_mfma_f32_16x16x32_bf16 v[100:103], v[224:227], v[140:143], v[100:103]
    ds_read_b64_tr_b16 v[228:229], v4 offset:34816
    ds_read_b64_tr_b16 v[230:231], v4 offset:38912
    buffer_load_dwordx4 v[220:223], v2, s[60:63], s83 offen offset:2048 sc1
    v_mfma_f32_16x16x32_bf16 v[108:111], v[232:235], v[140:143], v[108:111]
    ds_read_b64_tr_b16 v[236:237], v5 offset:34816
    ds_read_b64_tr_b16 v[238:239], v5 offset:38912
    v_mfma_f32_16x16x32_bf16 v[116:119], v[240:243], v[140:143], v[116:119]
    ds_read_b64_tr_b16 v[244:245], v6 offset:34816
    ds_read_b64_tr_b16 v[246:247], v6 offset:38912
    v_mfma_f32_16x16x32_bf16 v[124:127], v[248:251], v[140:143], v[124:127]
    ds_read_b64_tr_b16 v[252:253], v7 offset:34816
    ds_read_b64_tr_b16 v[254:255], v7 offset:38912
    buffer_load_dwordx4 v[132:135], v2, s[60:63], s82 offen offset:3072 sc1
    buffer_load_dwordx4 v[140:143], v2, s[60:63], s83 offen offset:3072 sc1
    s_waitcnt vmcnt(4)
    v_cmp_ne_u32 vcc, s12, v28
    s_nop 0
    s_and_b64 vcc, vcc, s[20:21]
    s_cbranch_scc0 L_ok20
    s_mov_b32 s86, 0
L_sp21:
    s_sleep 1
    buffer_load_dword v28, v27, s[60:63], s84 offen sc1
    s_waitcnt vmcnt(0)
    v_cmp_ne_u32 vcc, s12, v28
    s_nop 0
    s_and_b64 vcc, vcc, s[20:21]
    s_cbranch_scc0 L_ok20
    s_add_u32 s86, s86, 1
    s_and_b32 vcc_lo, s86, 7
    s_cbranch_scc1 L_sp21
    buffer_load_dword v28, v27, s[60:63], s24 offen sc1
    s_waitcnt vmcnt(0)
    v_cmp_ne_u32 vcc, s12, v28
    v_mov_b32 v28, 0
    s_and_b32 vcc_lo, vcc_lo, 0xff00
    s_cbranch_scc0 L_ok20
    s_cmp_lt_u32 s86, 0x100000
    s_cbranch_scc1 L_sp21
L_ok20:
    buffer_load_dwordx4 v[164:167], v29, s[60:63], s80 offen offset:2048 sc1
    buffer_load_dwordx4 v[172:175], v29, s[60:63], s81 offen offset:2048 sc1
    buffer_load_dword v22, v21, s[60:63], s99 offen offset:0 sc1
    buffer_load_dword v23, v21, s[60:63], s99 offen offset:128 sc1
    buffer_load_dword v25, v16, s[60:63], s99 offen offset:0 sc1
    buffer_load_dword v26, v16, s[60:63], s99 offen offset:128 sc1
    buffer_load_dwordx4 v[180:183], v29, s[60:63], s80 offen offset:3072 sc1
    buffer_load_dwordx4 v[188:191], v29, s[60:63], s81 offen offset:3072 sc1
    buffer_load_dwordx4 v[196:199], v31, s[60:63], s80 offen offset:0 sc1
    buffer_load_dwordx4 v[204:207], v31, s[60:63], s81 offen offset:0 sc1
    v_mfma_f32_16x16x32_bf16 v[96:99], v[64:67], v[148:151], v[96:99]
    v_add_u32 v13, 0x10000, v8
    ds_read_b64_tr_b16 v[128:129], v13 offset:0
    ds_read_b64_tr_b16 v[130:131], v13 offset:4096
    v_add_u32 v13, 0x10000, v9
    ds_read_b64_tr_b16 v[136:137], v13 offset:0
    ds_read_b64_tr_b16 v[138:139], v13 offset:4096
    v_mfma_f32_16x16x32_bf16 v[104:107], v[68:71], v[148:151], v[104:107]
    v_add_u32 v13, 0x10000, v10
    ds_read_b64_tr_b16 v[144:145], v13 offset:0
    ds_read_b64_tr_b16 v[146:147], v13 offset:4096
    v_add_u32 v13, 0x10000, v11
    ds_read_b64_tr_b16 v[152:153], v13 offset:0
    ds_read_b64_tr_b16 v[154:155], v13 offset:4096
    v_mfma_f32_16x16x32_bf16 v[112:115], v[72:75], v[148:151], v[112:115]
    v_mfma_f32_16x16x32_bf16 v[120:123], v[76:79], v[148:151], v[120:123]
    v_mfma_f32_16x16x32_bf16 v[100:103], v[64:67], v[156:159], v[100:103]
    v_mfma_f32_16x16x32_bf16 v[108:111], v[68:71], v[156:159], v[108:111]
    v_mfma_f32_16x16x32_bf16 v[116:119], v[72:75], v[156:159], v[116:119]
    v_mfma_f32_16x16x32_bf16 v[124:127], v[76:79], v[156:159], v[124:127]
    s_waitcnt vmcnt(9) lgkmcnt(14)
    v_mfma_f32_16x16x32_bf16 v[96:99], v[80:83], v[164:167], v[96:99]
    buffer_load_dwordx4 v[148:151], v29, s[60:63], s82 offen offset:0 sc1
    v_mfma_f32_16x16x32_bf16 v[104:107], v[84:87], v[164:167], v[104:107]
    v_mfma_f32_16x16x32_bf16 v[112:115], v[88:91], v[164:167], v[112:115]
    buffer_load_dwordx4 v[156:159], v29, s[60:63], s83 offen offset:0 sc1
    v_mfma_f32_16x16x32_bf16 v[120:123], v[92:95], v[164:167], v[120:123]
    s_waitcnt vmcnt(10)
    v_mfma_f32_16x16x32_bf16 v[100:103], v[80:83], v[172:175], v[100:103]
    v_mfma_f32_16x16x32_bf16 v[108:111], v[84:87], v[172:175], v[108:111]
    v_mfma_f32_16x16x32_bf16 v[116:119], v[88:91], v[172:175], v[116:119]
    v_mfma_f32_16x16x32_bf16 v[124:127], v[92:95], v[172:175], v[124:127]
    s_waitcnt vmcnt(9)
    v_sub_f32 v22, 1.0, v22
    s_waitcnt vmcnt(8)
    v_sub_f32 v23, 1.0, v23
    s_waitcnt vmcnt(7)
    v_sub_f32 v25, 1.0, v25
    s_waitcnt vmcnt(6)
    v_sub_f32 v26, 1.0, v26
    v_mul_f32 v96, v96, v22
    v_mul_f32 v97, v97, v22
    v_mul_f32 v98, v98, v22
    v_mul_f32 v99, v99, v22
    v_mul_f32 v104, v104, v22
    v_mul_f32 v105, v105, v22
    v_mul_f32 v106, v106, v22
    v_mul_f32 v107, v107, v22
    s_waitcnt vmcnt(5)
    v_mfma_f32_16x16x32_bf16 v[96:99], v[228:231], v[180:183], v[96:99]
    v_mul_f32 v112, v112, v22
    v_mul_f32 v113, v113, v22
    v_mul_f32 v114, v114, v22
    v_mul_f32 v115, v115, v22
    buffer_load_dwordx4 v[164:167], v29, s[60:63], s82 offen offset:1024 sc1
    s_waitcnt lgkmcnt(12)
    v_mfma_f32_16x16x32_bf16 v[104:107], v[236:239], v[180:183], v[104:107]
    v_mul_f32 v120, v120, v22
    v_mul_f32 v121, v121, v22
    v_mul_f32 v122, v122, v22
    v_mul_f32 v123, v123, v22
    s_waitcnt lgkmcnt(10)
    v_mfma_f32_16x16x32_bf16 v[112:115], v[244:247], v[180:183], v[112:115]
    v_mul_f32 v100, v100, v23
    v_mul_f32 v101, v101, v23
    v_mul_f32 v102, v102, v23
    v_mul_f32 v103, v103, v23
    buffer_load_dwordx4 v[172:175], v29, s[60:63], s83 offen offset:1024 sc1
    s_waitcnt lgkmcnt(8)
    v_mfma_f32_16x16x32_bf16 v[120:123], v[252:255], v[180:183], v[120:123]
    v_mul_f32 v108, v108, v23
    v_mul_f32 v109, v109, v23
    v_mul_f32 v110, v110, v23
    v_mul_f32 v111, v111, v23
    s_waitcnt vmcnt(6)
    v_mfma_f32_16x16x32_bf16 v[100:103], v[228:231], v[188:191], v[100:103]
    v_mul_f32 v116, v116, v23
    v_mul_f32 v117, v117, v23
    v_mul_f32 v118, v118, v23
    v_mul_f32 v119, v119, v23
    v_mfma_f32_16x16x32_bf16 v[108:111], v[236:239], v[188:191], v[108:111]
    v_mul_f32 v124, v124, v23
    v_mul_f32 v125, v125, v23
    v_mul_f32 v126, v126, v23
    v_mul_f32 v127, v127, v23
    v_mfma_f32_16x16x32_bf16 v[116:119], v[244:247], v[188:191], v[116:119]
    s_nop 0
    v_mfma_f32_16x16x32_bf16 v[124:127], v[252:255], v[188:191], v[124:127]
    s_waitcnt vmcnt(5) lgkmcnt(4)
    v_mfma_f32_16x16x32_bf16 v[104:107], v[136:139], v[196:199], v[104:107]
    buffer_load_dwordx4 v[180:183], v29, s[60:63], s82 offen offset:2048 sc1
    s_waitcnt lgkmcnt(2)
    v_mfma_f32_16x16x32_bf16 v[112:115], v[144:147], v[196:199], v[112:115]
    s_waitcnt lgkmcnt(0)
    v_mfma_f32_16x16x32_bf16 v[120:123], v[152:155], v[196:199], v[120:123]
    buffer_load_dwordx4 v[188:191], v29, s[60:63], s83 offen offset:2048 sc1
    s_waitcnt vmcnt(6)
    v_mfma_f32_16x16x32_bf16 v[108:111], v[136:139], v[204:207], v[108:111]
    v_mfma_f32_16x16x32_bf16 v[116:119], v[144:147], v[204:207], v[116:119]
    v_mfma_f32_16x16x32_bf16 v[124:127], v[152:155], v[204:207], v[124:127]
    v_mfma_f32_16x16x32_bf16 v[96:99], v[128:131], v[196:199], v[96:99]
    v_mfma_f32_16x16x32_bf16 v[100:103], v[128:131], v[204:207], v[100:103]
    v_mfma_f32_16x16x32_bf16 v[32:35], v[160:163], v[212:215], v[32:35]
    ds_write_b128 v17, v[104:107] offset:0
    s_nop 1
    ds_write_b128 v17, v[108:111] offset:1024
    buffer_load_dwordx4 v[196:199], v29, s[60:63], s82 offen offset:3072 sc1
    v_mfma_f32_16x16x32_bf16 v[40:43], v[168:171], v[212:215], v[40:43]
    ds_write_b128 v18, v[112:115] offset:16384
    ds_write_b128 v18, v[116:119] offset:17408
    v_mfma_f32_16x16x32_bf16 v[48:51], v[176:179], v[212:215], v[48:51]
    ds_write_b128 v19, v[120:123] offset:32768
    ds_write_b128 v19, v[124:127] offset:33792
    buffer_load_dwordx4 v[204:207], v29, s[60:63], s83 offen offset:3072 sc1
    v_mfma_f32_16x16x32_bf16 v[56:59], v[184:187], v[212:215], v[56:59]
    v_mfma_f32_16x16x32_bf16 v[36:39], v[160:163], v[220:223], v[36:39]
    v_mfma_f32_16x16x32_bf16 v[44:47], v[168:171], v[220:223], v[44:47]
    v_mfma_f32_16x16x32_bf16 v[52:55], v[176:179], v[220:223], v[52:55]
    v_mfma_f32_16x16x32_bf16 v[60:63], v[184:187], v[220:223], v[60:63]
    s_waitcnt lgkmcnt(0)
    s_barrier
    ds_read_b128 v[104:107], v20 offset:0
    ds_read_b128 v[108:111], v20 offset:1024
    ds_read_b128 v[112:115], v20 offset:16384
    ds_read_b128 v[116:119], v20 offset:17408
    ds_read_b128 v[120:123], v20 offset:32768
    ds_read_b128 v[124:127], v20 offset:33792
    v_mfma_f32_16x16x32_bf16 v[32:35], v[192:195], v[132:135], v[32:35]
    s_mov_b32 s13, 0x07060501
    s_mov_b32 s14, 0x07060502
    s_mov_b32 s15, 0x07060503
    s_waitcnt lgkmcnt(5)
    v_add_f32 v96, v96, v104
    buffer_load_dwordx4 v[212:215], v31, s[60:63], s82 offen offset:0 sc1
    v_mfma_f32_16x16x32_bf16 v[40:43], v[200:203], v[132:135], v[40:43]
    v_add_f32 v97, v97, v105
    v_add_f32 v98, v98, v106
    v_add_f32 v99, v99, v107
    s_waitcnt lgkmcnt(1)
    v_add_f32 v112, v112, v120
    v_mfma_f32_16x16x32_bf16 v[48:51], v[208:211], v[132:135], v[48:51]
    v_add_f32 v113, v113, v121
    v_add_f32 v114, v114, v122
    v_add_f32 v115, v115, v123
    v_add_f32 v96, v96, v112
    buffer_load_dwordx4 v[220:223], v31, s[60:63], s83 offen offset:0 sc1
    v_mfma_f32_16x16x32_bf16 v[56:59], v[216:219], v[132:135], v[56:59]
    v_add_f32 v97, v97, v113
    v_add_f32 v98, v98, v114
    v_add_f32 v99, v99, v115
    v_perm_b32 v104, v96, v99, s13
    v_mfma_f32_16x16x32_bf16 v[36:39], v[192:195], v[140:143], v[36:39]
    v_perm_b32 v105, v97, v99, s14
    v_perm_b32 v106, v98, v99, s15
    v_mov_b32 v107, s12
    v_add_f32 v100, v100, v108
    v_mfma_f32_16x16x32_bf16 v[44:47], v[200:203], v[140:143], v[44:47]
    v_add_f32 v101, v101, v109
    v_add_f32 v102, v102, v110
    v_add_f32 v103, v103, v111
    s_waitcnt lgkmcnt(0)
    v_add_f32 v116, v116, v124
    v_mfma_f32_16x16x32_bf16 v[52:55], v[208:211], v[140:143], v[52:55]
    v_add_f32 v117, v117, v125
    v_add_f32 v118, v118, v126
    v_add_f32 v119, v119, v127
    v_add_f32 v100, v100, v116
    v_mfma_f32_16x16x32_bf16 v[60:63], v[216:219], v[140:143], v[60:63]
    v_add_f32 v101, v101, v117
    v_add_f32 v102, v102, v118
    v_add_f32 v103, v103, v119
    v_perm_b32 v108, v100, v103, s13
    v_perm_b32 v109, v101, v103, s14
    v_perm_b32 v110, v102, v103, s15
    v_mov_b32 v111, s12
    v_add_u32 v17, -65536, v17
    v_add_u32 v18, -65536, v18
    v_add_u32 v19, -65536, v19
    v_add_u32 v20, -65536, v20
    buffer_store_dwordx4 v[104:107], v2, s[60:63], s98 offen offset:0 sc1
    buffer_store_dwordx4 v[108:111], v2, s[60:63], s98 offen offset:1024 sc1
    s_waitcnt vmcnt(11)
    v_mfma_f32_16x16x32_bf16 v[32:35], v[224:227], v[148:151], v[32:35]
    v_mfma_f32_16x16x32_bf16 v[40:43], v[232:235], v[148:151], v[40:43]
    v_mfma_f32_16x16x32_bf16 v[48:51], v[240:243], v[148:151], v[48:51]
    v_mfma_f32_16x16x32_bf16 v[56:59], v[248:251], v[148:151], v[56:59]
    s_waitcnt vmcnt(10)
    v_mfma_f32_16x16x32_bf16 v[36:39], v[224:227], v[156:159], v[36:39]
    v_mfma_f32_16x16x32_bf16 v[44:47], v[232:235], v[156:159], v[44:47]
    v_mfma_f32_16x16x32_bf16 v[52:55], v[240:243], v[156:159], v[52:55]
    v_mfma_f32_16x16x32_bf16 v[60:63], v[248:251], v[156:159], v[60:63]
    s_waitcnt vmcnt(9)
    v_mfma_f32_16x16x32_bf16 v[32:35], v[64:67], v[164:167], v[32:35]
    v_lshlrev_b32 v168, 16, v14
    v_and_b32 v169, 0xffff0000, v14
    v_mfma_f32_16x16x32_bf16 v[40:43], v[68:71], v[164:167], v[40:43]
    v_lshlrev_b32 v170, 16, v15
    v_and_b32 v171, 0xffff0000, v15
    v_mfma_f32_16x16x32_bf16 v[48:51], v[72:75], v[164:167], v[48:51]
    v_mfma_f32_16x16x32_bf16 v[56:59], v[76:79], v[164:167], v[56:59]
    s_waitcnt vmcnt(8)
    v_mfma_f32_16x16x32_bf16 v[36:39], v[64:67], v[172:175], v[36:39]
    v_mfma_f32_16x16x32_bf16 v[44:47], v[68:71], v[172:175], v[44:47]
    v_mfma_f32_16x16x32_bf16 v[52:55], v[72:75], v[172:175], v[52:55]
    v_mfma_f32_16x16x32_bf16 v[60:63], v[76:79], v[172:175], v[60:63]
    s_waitcnt vmcnt(7)
    v_mfma_f32_16x16x32_bf16 v[32:35], v[80:83], v[180:183], v[32:35]
    v_mfma_f32_16x16x32_bf16 v[40:43], v[84:87], v[180:183], v[40:43]
    v_mfma_f32_16x16x32_bf16 v[48:51], v[88:91], v[180:183], v[48:51]
    v_mfma_f32_16x16x32_bf16 v[56:59], v[92:95], v[180:183], v[56:59]
    s_waitcnt vmcnt(6)
    v_mfma_f32_16x16x32_bf16 v[36:39], v[80:83], v[188:191], v[36:39]
    v_mfma_f32_16x16x32_bf16 v[44:47], v[84:87], v[188:191], v[44:47]
    v_mfma_f32_16x16x32_bf16 v[52:55], v[88:91], v[188:191], v[52:55]
    v_mfma_f32_16x16x32_bf16 v[60:63], v[92:95], v[188:191], v[60:63]
    v_mul_f32 v32, v32, v25
    v_mul_f32 v33, v33, v25
    v_mul_f32 v34, v34, v25
    v_mul_f32 v35, v35, v25
    v_mul_f32 v40, v40, v25
    v_mul_f32 v41, v41, v25
    v_mul_f32 v42, v42, v25
    v_mul_f32 v43, v43, v25
    s_waitcnt vmcnt(5)
    v_mfma_f32_16x16x32_bf16 v[32:35], v[228:231], v[196:199], v[32:35]
    v_mul_f32 v48, v48, v25
    v_mul_f32 v49, v49, v25
    v_mul_f32 v50, v50, v25
    v_mul_f32 v51, v51, v25
    v_mfma_f32_16x16x32_bf16 v[40:43], v[236:239], v[196:199], v[40:43]
    v_mul_f32 v56, v56, v25
    v_mul_f32 v57, v57, v25
    v_mul_f32 v58, v58, v25
    v_mul_f32 v59, v59, v25
    v_mfma_f32_16x16x32_bf16 v[48:51], v[244:247], v[196:199], v[48:51]
    v_mul_f32 v36, v36, v26
    v_mul_f32 v37, v37, v26
    v_mul_f32 v38, v38, v26
    v_mul_f32 v39, v39, v26
    v_mfma_f32_16x16x32_bf16 v[56:59], v[252:255], v[196:199], v[56:59]
    v_mul_f32 v44, v44, v26
    v_mul_f32 v45, v45, v26
    v_mul_f32 v46, v46, v26
    v_mul_f32 v47, v47, v26
    s_waitcnt vmcnt(3)
    v_mfma_f32_16x16x32_bf16 v[40:43], v[136:139], v[212:215], v[40:43]
    v_mul_f32 v52, v52, v26
    v_mul_f32 v53, v53, v26
    v_mul_f32 v54, v54, v26
    v_mul_f32 v55, v55, v26
    v_mfma_f32_16x16x32_bf16 v[48:51], v[144:147], v[212:215], v[48:51]
    v_mul_f32 v60, v60, v26
    v_mul_f32 v61, v61, v26
    v_mul_f32 v62, v62, v26
    v_mul_f32 v63, v63, v26
    v_mfma_f32_16x16x32_bf16 v[56:59], v[152:155], v[212:215], v[56:59]
    v_mfma_f32_16x16x32_bf16 v[32:35], v[128:131], v[212:215], v[32:35]
    v_mfma_f32_16x16x32_bf16 v[36:39], v[228:231], v[204:207], v[36:39]
    s_nop 0
    s_nop 0
    v_mfma_f32_16x16x32_bf16 v[44:47], v[236:239], v[204:207], v[44:47]
    s_nop 0
    s_nop 0
    v_mfma_f32_16x16x32_bf16 v[52:55], v[244:247], v[204:207], v[52:55]
    ds_write_b128 v17, v[40:43] offset:0
    ds_write_b128 v18, v[48:51] offset:16384
    v_mfma_f32_16x16x32_bf16 v[60:63], v[252:255], v[204:207], v[60:63]
    ds_write_b128 v19, v[56:59] offset:32768
    s_waitcnt vmcnt(2)
    v_mfma_f32_16x16x32_bf16 v[44:47], v[136:139], v[220:223], v[44:47]
    v_mfma_f32_16x16x32_bf16 v[52:55], v[144:147], v[220:223], v[52:55]
    v_mfma_f32_16x16x32_bf16 v[60:63], v[152:155], v[220:223], v[60:63]
    v_mfma_f32_16x16x32_bf16 v[36:39], v[128:131], v[220:223], v[36:39]
    s_nop 4
    ds_write_b128 v17, v[44:47] offset:1024
    ds_write_b128 v18, v[52:55] offset:17408
    ds_write_b128 v19, v[60:63] offset:33792
    s_xor_b32 s98, s98, 0x8000
    buffer_load_dwordx4 v[192:195], v2, s[60:63], s98 offen offset:0 sc1
    buffer_load_dwordx4 v[200:203], v2, s[60:63], s98 offen offset:1024 sc1
    v_fma_f32 v32, v168, v25, v32
    v_fma_f32 v33, v169, v25, v33
    v_fma_f32 v34, v170, v25, v34
    v_fma_f32 v35, v171, v25, v35
    v_fma_f32 v36, v168, v26, v36
    v_fma_f32 v37, v169, v26, v37
    v_fma_f32 v38, v170, v26, v38
    v_fma_f32 v39, v171, v26, v39
    s_mov_b32 s13, 0x4000
    s_waitcnt lgkmcnt(0)
    s_barrier
    ds_read_b128 v[40:43], v20 offset:0
    ds_read_b128 v[48:51], v20 offset:16384
    ds_read_b128 v[56:59], v20 offset:32768
    ds_read_b128 v[44:47], v20 offset:1024
    ds_read_b128 v[52:55], v20 offset:17408
    ds_read_b128 v[60:63], v20 offset:33792
    s_waitcnt lgkmcnt(5)
    v_add_f32 v32, v32, v40
    v_add_f32 v33, v33, v41
    v_add_f32 v34, v34, v42
    v_add_f32 v35, v35, v43
    s_waitcnt lgkmcnt(3)
    v_add_f32 v48, v48, v56
    v_add_f32 v49, v49, v57
    v_add_f32 v50, v50, v58
    v_add_f32 v51, v51, v59
    v_add_f32 v32, v32, v48
    v_add_f32 v33, v33, v49
    v_add_f32 v34, v34, v50
    v_add_f32 v35, v35, v51
    s_waitcnt lgkmcnt(2)
    v_add_f32 v36, v36, v44
    v_add_f32 v37, v37, v45
    v_add_f32 v38, v38, v46
    v_add_f32 v39, v39, v47
    s_waitcnt lgkmcnt(0)
    v_add_f32 v52, v52, v60
    v_add_f32 v53, v53, v61
    v_add_f32 v54, v54, v62
    v_add_f32 v55, v55, v63
    v_add_f32 v36, v36, v52
    v_add_f32 v37, v37, v53
    v_add_f32 v38, v38, v54
    v_add_f32 v39, v39, v55
    s_waitcnt vmcnt(1)
    v_xor_b32 v24, s12, v195
    s_waitcnt vmcnt(0)
    v_xor_b32 v22, s12, v203
    v_or_b32 v24, v24, v22
    v_cmp_ne_u32 vcc, 0, v24
    s_nop 1
    s_cbranch_vccz L_ok22
    s_mov_b32 s86, 0
L_sp23:
    buffer_load_dwordx4 v[192:195], v2, s[60:63], s98 offen offset:0 sc1
    buffer_load_dwordx4 v[200:203], v2, s[60:63], s98 offen offset:1024 sc1
    s_mov_b64 exec, -1
    s_waitcnt vmcnt(0)
    v_xor_b32 v24, s12, v195
    v_xor_b32 v22, s12, v203
    v_or_b32 v24, v24, v22
    v_cmp_ne_u32 vcc, 0, v24
    s_nop 1
    s_cbranch_vccz L_ok22
    s_sleep 1
    s_add_u32 s86, s86, 1
    s_cmp_lt_u32 s86, 0x100000
    s_cbranch_scc1 L_sp23
L_ok22:
    s_mov_b32 s14, 0x0c04000c
    s_mov_b32 s15, 0x04020100
    v_perm_b32 v195, v193, v192, s14
    v_perm_b32 v195, v194, v195, s15
    v_add_f32 v32, v32, v192
    v_add_f32 v33, v33, v193
    v_add_f32 v34, v34, v194
    v_add_f32 v35, v35, v195
    v_cvt_pk_bf16_f32 v176, v32, v33
    v_cvt_pk_bf16_f32 v177, v34, v35
    buffer_store_dwordx2 v[176:177], v12, s[64:67], 0 offen
    v_perm_b32 v203, v201, v200, s14
    v_perm_b32 v203, v202, v203, s15
    v_add_f32 v36, v36, v200
    v_add_f32 v37, v37, v201
    v_add_f32 v38, v38, v202
    v_add_f32 v39, v39, v203
    v_cvt_pk_bf16_f32 v178, v36, v37
    v_cvt_pk_bf16_f32 v179, v38, v39
    buffer_store_dwordx2 v[178:179], v12, s[64:67], s13 offen
    s_endpgm
L_end:
    s_endpgm
.fill 1200, 4, 0xbf810000
.section .rodata,"a"
.p2align 6
.amdhsa_kernel gated_mix__linear_attn_block__dense_activation_squared_relu__prompt_kernel
  .amdhsa_next_free_vgpr 256
  .amdhsa_next_free_sgpr 102
  .amdhsa_accum_offset 256
  .amdhsa_group_segment_fixed_size 0
  .amdhsa_kernarg_size 96
  .amdhsa_user_sgpr_count 2
  .amdhsa_user_sgpr_kernarg_segment_ptr 1
  .amdhsa_system_sgpr_workgroup_id_x 1
.end_amdhsa_kernel
```
